```python
import torch

def _softmax(x, axis=-1):
    return torch.softmax(x, dim=axis)
def _gelu(x):
    return torch.nn.functional.gelu(x, approximate="tanh")
def _silu(x):
    return torch.nn.functional.silu(x)
def _sigmoid(x):
    return torch.sigmoid(x)
def _layernorm(x, axis=-1, eps=1e-5):
    m = x.mean(dim=axis, keepdim=True)
    v = x.var(dim=axis, keepdim=True, unbiased=False)
    return (x - m) / torch.sqrt(v + eps)
def _scatter_add(tgt, idx, src, axis=0):
    return tgt.clone().index_add_(axis, idx, src)
def _segment_sum(src, seg, n):
    out = torch.zeros((n,) + src.shape[1:], dtype=src.dtype)
    return out.index_add_(0, seg, src)
def _pad(x, pw):
    flat = tuple(v for pair in reversed(pw) for v in pair)
    return torch.nn.functional.pad(x, flat)

kernel_name = 'recurrent_scan__softmax_full_mha__moe_arch_mod__prompt'

def setup_inputs():

    _w = (lambda a: (lambda t: t.to(torch.bfloat16) if t.is_floating_point() else t)(torch.as_tensor(a)))
    def _A_setup():
        B, S, D = 1, 2048, 512
        return {
            "x": _w((lambda *s: torch.randn(*s, dtype=torch.bfloat16) * 0.05)(B, S, D)),
            "wqkv": _w((lambda *s: torch.randn(*s, dtype=torch.bfloat16) * 0.05)(D, 3 * D)),
            "wo": _w((lambda *s: torch.randn(*s, dtype=torch.bfloat16) * 0.05)(D, D)),
        }
    _A_in = _A_setup()

    def _B_setup():
        B, S, D, F, C = 1, 2048, 512, 1792, 2
        return {
            "x": _w((lambda *s: torch.randn(*s, dtype=torch.bfloat16) * 0.05)(B, S, D)),
            "w_r": _w((lambda *s: torch.randn(*s, dtype=torch.bfloat16) * 0.05)(D)),
            "w_gate": _w((lambda *s: torch.randn(*s, dtype=torch.bfloat16) * 0.05)(D, F)),
            "w_up": _w((lambda *s: torch.randn(*s, dtype=torch.bfloat16) * 0.05)(D, F)),
            "w_down": _w((lambda *s: torch.randn(*s, dtype=torch.bfloat16) * 0.05)(F, D)),
        }
    _B_in = _B_setup()

    return {
        "A_x": _A_in["x"],
        "A_wqkv": _A_in["wqkv"],
        "A_wo": _A_in["wo"],
        "B_x": _B_in["x"],
        "B_w_r": _B_in["w_r"],
        "B_w_gate": _B_in["w_gate"],
        "B_w_up": _B_in["w_up"],
        "B_w_down": _B_in["w_down"],
    }

def reference(A_x, A_wqkv, A_wo, B_x, B_w_r, B_w_gate, B_w_up, B_w_down):
    def _A_ref(x, wqkv, wo):
        B, S, D = x.shape
        H = 32; Dh = D // H
        qkv = (lambda x, *d: x.permute(*d))((x @ wqkv).reshape(B, S, 3, H, Dh), 2, 0, 3, 1, 4)
        q, k, v = qkv[0], qkv[1], qkv[2]
        scale = Dh ** -0.5
        scores = torch.einsum("bhqd,bhkd->bhqk", q, k) * scale
        p = _softmax(scores, axis=-1)
        o = torch.einsum("bhqk,bhkd->bhqd", p, v)
        return (lambda x, *d: x.permute(*d))(o, 0, 2, 1, 3).reshape(B, S, D) @ wo

    def _B_ref(x, w_r, w_gate, w_up, w_down):
        B, S, D = x.shape
        C = 2
        r = x @ w_r
        idx = torch.argsort(-r, axis=-1)[:, :C]
        idx_e = (lambda x, n, axis: torch.repeat_interleave(x, n, dim=axis))(idx.reshape(B, C, 1), D, axis=2)
        x_sel = (lambda x, i, axis: torch.take_along_dim(x, i, dim=axis))(x, idx_e, axis=1)
        g = _silu(x_sel @ w_gate)
        u = x_sel @ w_up
        y = (g * u) @ w_down
        r_sel = _sigmoid((lambda x, i, axis: torch.take_along_dim(x, i, dim=axis))(r, idx, axis=1))
        y = y * r_sel.reshape(B, C, 1)
        b_off = (torch.arange(B) * S).reshape(B, 1)
        flat_idx = (idx + b_off).reshape(B * C)
        zero = (x * 0.0).reshape(B * S, D)
        upd = _scatter_add(zero, flat_idx, y.reshape(B * C, D), axis=0)
        return x + upd.reshape(B, S, D)

    x = A_x
    xn = _layernorm(x, axis=-1)
    s = _A_ref(xn, A_wqkv, A_wo)
    g = _silu(_B_ref(xn, B_w_r, B_w_gate, B_w_up, B_w_down))
    return x + s * g
```

```asm
; @launch grid=(256,1,1) block=(512,1,1) lds=163840
.amdgcn_target "amdgcn-amd-amdhsa--gfx950"
.text
.globl recurrent_scan__softmax_full_mha__moe_arch_mod__prompt_kernel
.p2align 8
.type recurrent_scan__softmax_full_mha__moe_arch_mod__prompt_kernel,@function
recurrent_scan__softmax_full_mha__moe_arch_mod__prompt_kernel:
    s_cmp_ge_u32 s2, 256
    s_cbranch_scc1 L_end
    s_load_dwordx2 s[8:9], s[0:1], 0
    s_load_dwordx2 s[12:13], s[0:1], 8
    s_load_dwordx2 s[40:41], s[0:1], 32
    v_readfirstlane_b32 s3, v0
    v_and_b32 v0, 63, v0
    s_and_b32 s5, s2, 7
    s_lshr_b32 s4, s2, 3
    s_mov_b32 s10, 2097152
    s_mov_b32 s11, 0x20000
    s_mov_b32 s18, 16777216
    s_mov_b32 s19, 0x20000
    v_lshlrev_b32 v1, 4, v0
    v_lshrrev_b32 v152, 4, v0
    s_lshr_b32 s3, s3, 6
    s_and_b32 s6, s3, 3
    s_lshl_b32 s55, s6, 10
    s_lshr_b32 s7, s3, 2
    s_cbranch_scc1 L_loader
    s_lshr_b32 s52, s2, 3
    s_getpc_b64 s[60:61]
L_pc:
    s_lshl_b32 s51, s52, 2
    s_add_u32 s51, s51, s6
    s_mul_i32 s51, s51, 320
    s_min_u32 s51, s51, L_end-L_pc-320
    s_add_u32 s60, s60, s51
    s_addc_u32 s61, s61, 0
    s_load_dword s54, s[60:61], 0
    s_load_dword s54, s[60:61], 64
    s_load_dword s54, s[60:61], 128
    s_load_dword s54, s[60:61], 192
    s_load_dword s54, s[60:61], 256
    s_branch L_compute
L_loader:
    s_setprio 1
    s_lshl_b32 s46, s5, 1
    s_add_u32 s46, s46, s4
    s_and_b32 s46, s46, 7
    v_lshrrev_b32 v150, 3, v0
    v_and_b32 v151, 7, v0
    s_and_b32 s49, s3, 1
    s_lshl_b32 s49, s49, 2
    v_xor_b32 v154, s49, v151
    s_lshl_b32 s50, s4, 3
    s_add_u32 s50, s50, s6
    s_lshl_b32 s50, s50, 13
    v_xor_b32 v153, v154, v152
    v_lshl_add_u32 v246, v150, 6, v153
    v_lshl_add_u32 v246, v246, 4, s50
    v_and_b32 v247, 2, v150
    v_xor_b32 v154, v154, v247
    s_mul_i32 s50, s6, 24576
    s_lshl_b32 s51, s5, 7
    s_add_u32 s50, s50, s51
    v_mul_u32_u24 v247, 192, v150
    v_add_lshl_u32 v247, v247, v154, 4
    v_add_u32 v247, s50, v247
    s_mov_b32 s47, s46
    s_mov_b32 s48, s46
    s_mov_b32 s14, 1572864
    s_mov_b32 s15, 0x20000
    s_mov_b32 s42, 1024
    s_mov_b32 s43, 0x20000
    s_waitcnt lgkmcnt(0)
    s_lshl_b32 s49, s47, 7
    s_add_u32 m0, s55, 0
    s_add_u32 s47, s47, 1
    buffer_load_dwordx4 v246, s[8:11], s49 offen  lds
    s_and_b32 s47, s47, 7
    s_add_u32 m0, s55, 4096
    s_add_u32 s49, s49, 32768
    buffer_load_dwordx4 v246, s[8:11], s49 offen  lds
    s_mul_i32 s50, s48, 196608
    s_add_u32 m0, s55, 65536
    s_add_u32 s50, s50, 1024
    buffer_load_dwordx4 v247, s[12:15], s50 offen  lds
    s_add_u32 m0, s55, 69632
    s_add_u32 s50, s50, 98304
    buffer_load_dwordx4 v247, s[12:15], s50 offen  lds
    s_load_dwordx2 s[16:17], s[0:1], 80
    s_load_dwordx2 s[20:21], s[0:1], 16
    s_load_dwordx2 s[24:25], s[0:1], 64
    s_load_dwordx2 s[28:29], s[0:1], 40
    s_load_dwordx2 s[32:33], s[0:1], 48
    s_load_dwordx2 s[36:37], s[0:1], 56
    s_mul_i32 s50, s48, 196608
    s_add_u32 m0, s55, 73728
    s_add_u32 s50, s50, 2048
    buffer_load_dwordx4 v247, s[12:15], s50 offen  lds
    s_add_u32 m0, s55, 77824
    s_add_u32 s50, s50, 98304
    buffer_load_dwordx4 v247, s[12:15], s50 offen  lds
    s_add_u32 s48, s48, 1
    s_and_b32 s48, s48, 7
    s_lshl_b32 s51, s6, 1
    s_add_u32 s51, s51, s46
    v_add_u32 v153, s51, v150
    v_and_b32 v153, 7, v153
    v_lshlrev_b32 v153, 7, v153
    v_lshl_add_u32 v153, v151, 4, v153
    s_lshl_b32 s51, s6, 8
    s_add_u32 m0, s51, 155648
    s_mov_b64 exec, 0xffff
    buffer_load_dwordx4 v153, s[40:43], 0 offen lds
    s_mov_b64 exec, -1
    s_lshl_b32 s49, s47, 7
    s_add_u32 m0, s55, 8192
    s_add_u32 s47, s47, 1
    buffer_load_dwordx4 v246, s[8:11], s49 offen  lds
    s_and_b32 s47, s47, 7
    s_add_u32 m0, s55, 12288
    s_add_u32 s49, s49, 32768
    buffer_load_dwordx4 v246, s[8:11], s49 offen  lds
    s_waitcnt lgkmcnt(0)
    s_mov_b32 s82, 0x22222222
    s_mov_b32 s83, 0x22222222
    s_add_u32 s58, s16, 6291456
    s_addc_u32 s59, s17, 0
    s_load_dword s44, s[58:59], 0
    s_lshr_b32 s51, s4, 3
    s_lshl_b32 s1, s5, 2
    s_add_u32 s1, s1, s51
    s_and_b32 s0, s4, 7
    s_lshl_b32 s51, s5, 9
    s_add_u32 s51, s51, 6299648
    s_lshr_b32 s52, s55, 3
    s_add_u32 s51, s51, s52
    s_lshl_b32 s52, s1, 7
    s_add_u32 s52, s52, 6303744
    s_buffer_load_dword s54, s[16:19], s51
    s_buffer_load_dword s54, s[16:19], s51 offset:64
    s_buffer_load_dword s54, s[16:19], s52
    v_and_b32 v151, 15, v0
    v_lshrrev_b32 v153, 1, v151
    v_xor_b32 v153, v153, v152
    v_lshlrev_b32 v248, 7, v151
    v_lshl_add_u32 v248, v153, 4, v248
    v_xor_b32 v249, 64, v248
    v_bfe_u32 v150, v0, 2, 2
    v_bfe_u32 v153, v0, 3, 2
    v_and_b32 v154, 3, v0
    v_xor_b32 v153, s6, v153
    v_lshl_add_u32 v250, v152, 3, v150
    v_lshl_add_u32 v250, v250, 2, v153
    v_lshl_add_u32 v250, v250, 2, v154
    v_lshlrev_b32 v250, 3, v250
    v_add_u32 v250, 65536, v250
    v_add_u32 v251, 32768, v250
    v_mov_b32 v242, 0x3f803f80
    v_mov_b32 v243, v242
    v_mov_b64 v[244:245], v[242:243]
    v_lshl_add_u32 v190, s6, 11, v248
    v_xor_b32 v191, 64, v190
    v_lshrrev_b32 v192, 4, v0
    v_lshlrev_b32 v192, 4, v192
    v_add_u32 v192, 155648, v192
    v_and_b32 v193, 3, v0
    v_cmp_eq_u32 vcc, 0, v193
    s_nop 1
    v_cndmask_b32 v166, 0, v242, vcc
    v_mov_b32 v167, v166
    v_mov_b64 v[168:169], v[166:167]
    v_mov_b64 v[170:171], v[166:167]
    v_mov_b64 v[172:173], v[166:167]
    v_mov_b64 v[174:175], v[166:167]
    v_mov_b64 v[176:177], v[166:167]
    v_mov_b64 v[178:179], v[166:167]
    v_mov_b64 v[180:181], v[166:167]
    s_mov_b32 s22, 524288
    s_mov_b32 s23, 0x20000
    s_mov_b32 s26, 2097152
    s_mov_b32 s27, 0x20000
    s_mov_b32 s30, 1835008
    s_mov_b32 s31, 0x20000
    s_mov_b32 s38, 1835008
    s_mov_b32 s39, 0x20000
    s_mov_b32 s56, 0xffff
    s_mov_b32 s57, 0xffff
    s_lshl_b32 s45, s3, 10
    v_lshlrev_b32 v3, 2, v0
    v_mov_b32 v7, 0
    v_mov_b32 v6, 0xdddddddd
    v_and_b32 v200, 11, v0
    v_cmp_eq_u32 vcc, 0, v200
    v_add_u32 v25, s45, v1
    v_add_u32 v25, 98304, v25
    v_cndmask_b32 v76, 0, v242, vcc
    v_mov_b32 v77, v76
    v_mov_b64 v[78:79], v[76:77]
    v_mov_b64 v[80:81], v[76:77]
    v_mov_b64 v[82:83], v[76:77]
    v_mov_b64 v[88:89], v[76:77]
    v_mov_b64 v[90:91], v[76:77]
    v_mov_b64 v[92:93], v[76:77]
    v_mov_b64 v[94:95], v[76:77]
    v_mov_b64 v[100:101], v[76:77]
    v_mov_b64 v[102:103], v[76:77]
    v_mov_b64 v[104:105], v[76:77]
    v_mov_b64 v[106:107], v[76:77]
    s_mul_i32 s50, s48, 196608
    s_add_u32 m0, s55, 81920
    s_add_u32 s50, s50, 1024
    buffer_load_dwordx4 v247, s[12:15], s50 offen  lds
    s_add_u32 m0, s55, 86016
    s_add_u32 s50, s50, 98304
    buffer_load_dwordx4 v247, s[12:15], s50 offen  lds
    s_mul_i32 s50, s48, 196608
    s_add_u32 m0, s55, 90112
    s_add_u32 s50, s50, 2048
    buffer_load_dwordx4 v247, s[12:15], s50 offen  lds
    s_add_u32 m0, s55, 94208
    s_add_u32 s50, s50, 98304
    buffer_load_dwordx4 v247, s[12:15], s50 offen  lds
    s_add_u32 s48, s48, 1
    s_and_b32 s48, s48, 7
    s_lshl_b32 s49, s47, 7
    s_add_u32 m0, s55, 16384
    s_add_u32 s47, s47, 1
    buffer_load_dwordx4 v246, s[8:11], s49 offen  lds
    s_and_b32 s47, s47, 7
    s_add_u32 m0, s55, 20480
    s_add_u32 s49, s49, 32768
    buffer_load_dwordx4 v246, s[8:11], s49 offen  lds
    s_waitcnt vmcnt(8)
    s_barrier
    s_lshl_b32 s49, s47, 7
    s_add_u32 m0, s55, 24576
    s_add_u32 s47, s47, 1
    buffer_load_dwordx4 v246, s[8:11], s49 offen  lds
    s_and_b32 s47, s47, 7
    ds_read_b128 v[150:153], v190 offset:0
    ds_read_b128 v[154:157], v191 offset:0
    s_mov_b64 exec, s[82:83]
    ds_read_b128 v[166:169], v192 offset:0
    ds_read_b128 v[170:173], v192 offset:64
    s_mov_b64 exec, -1
    s_add_u32 m0, s55, 28672
    s_add_u32 s49, s49, 32768
    buffer_load_dwordx4 v246, s[8:11], s49 offen  lds
    v_add_u32 v193, 155648, v1
    ds_read_b128 v[194:197], v193
    v_mov_b64 v[112:113], v[76:77]
    v_mov_b64 v[114:115], v[76:77]
    v_mov_b64 v[116:117], v[76:77]
    v_mov_b64 v[118:119], v[76:77]
    s_mul_i32 s50, s48, 196608
    s_add_u32 m0, s55, 98304
    s_add_u32 s50, s50, 1024
    buffer_load_dwordx4 v247, s[12:15], s50 offen  lds
    v_mov_b64 v[124:125], v[76:77]
    v_mov_b64 v[126:127], v[76:77]
    v_mov_b64 v[128:129], v[76:77]
    v_mov_b64 v[130:131], v[76:77]
    v_mov_b64 v[136:137], v[76:77]
    v_mov_b64 v[138:139], v[76:77]
    v_mov_b64 v[140:141], v[76:77]
    v_mov_b64 v[142:143], v[76:77]
    s_add_u32 m0, s55, 102400
    s_add_u32 s50, s50, 98304
    buffer_load_dwordx4 v247, s[12:15], s50 offen  lds
    s_lshl_b32 s51, s5, 8
    s_add_u32 s51, s51, s3
    v_lshl_add_u32 v200, s51, 11, v1
    s_mul_i32 s50, s48, 196608
    s_add_u32 m0, s55, 106496
    s_add_u32 s50, s50, 2048
    buffer_load_dwordx4 v247, s[12:15], s50 offen  lds
    s_add_u32 s51, s4, 0
    s_and_b32 s51, s51, 3
    v_lshl_add_u32 v10, s51, 14, v200
    s_add_u32 m0, s55, 110592
    s_add_u32 s50, s50, 98304
    buffer_load_dwordx4 v247, s[12:15], s50 offen  lds
    s_add_u32 s48, s48, 1
    s_and_b32 s48, s48, 7
    s_waitcnt vmcnt(8)
    s_barrier
    s_lshl_b32 s49, s47, 7
    s_add_u32 m0, s55, 32768
    s_add_u32 s47, s47, 1
    buffer_load_dwordx4 v246, s[8:11], s49 offen  lds
    s_and_b32 s47, s47, 7
    s_waitcnt lgkmcnt(0)
    v_mfma_f32_16x16x32_bf16 v[182:185], v[150:153], v[150:153], 0
    v_mfma_f32_16x16x32_bf16 v[186:189], v[166:169], v[150:153], 0
    v_mfma_f32_16x16x32_bf16 v[182:185], v[154:157], v[154:157], v[182:185]
    v_mfma_f32_16x16x32_bf16 v[186:189], v[170:173], v[154:157], v[186:189]
    s_add_u32 m0, s55, 36864
    s_add_u32 s49, s49, 32768
    buffer_load_dwordx4 v246, s[8:11], s49 offen  lds
    ds_read_b128 v[150:153], v190 offset:8192
    ds_read_b128 v[154:157], v191 offset:8192
    s_mov_b64 exec, s[82:83]
    ds_read_b128 v[166:169], v192 offset:128
    ds_read_b128 v[170:173], v192 offset:192
    s_mov_b64 exec, -1
    s_mul_i32 s50, s48, 196608
    s_add_u32 m0, s55, 114688
    s_add_u32 s50, s50, 1024
    buffer_load_dwordx4 v247, s[12:15], s50 offen  lds
    s_add_u32 s51, s4, 1
    s_and_b32 s51, s51, 3
    v_lshl_add_u32 v11, s51, 14, v200
    s_add_u32 s51, s4, 2
    s_and_b32 s51, s51, 3
    v_lshl_add_u32 v12, s51, 14, v200
    s_add_u32 m0, s55, 118784
    s_add_u32 s50, s50, 98304
    buffer_load_dwordx4 v247, s[12:15], s50 offen  lds
    s_add_u32 s51, s4, 3
    s_and_b32 s51, s51, 3
    v_lshl_add_u32 v13, s51, 14, v200
    s_lshr_b32 s51, s4, 2
    s_lshl_b32 s53, s51, 16
    s_lshl_b32 s77, s5, 3
    s_add_u32 s77, s77, s51
    s_mul_i32 s50, s48, 196608
    s_add_u32 m0, s55, 122880
    s_add_u32 s50, s50, 2048
    buffer_load_dwordx4 v247, s[12:15], s50 offen  lds
    s_lshl_b32 s51, s5, 2
    s_add_u32 s51, s51, s6
    s_lshl_b32 s74, s51, 12
    s_add_u32 s74, s74, 6553600
    s_lshl_b32 s76, s51, 7
    s_add_u32 s76, s76, 6299648
    s_add_u32 m0, s55, 126976
    s_add_u32 s50, s50, 98304
    buffer_load_dwordx4 v247, s[12:15], s50 offen  lds
    s_add_u32 s48, s48, 1
    s_and_b32 s48, s48, 7
    s_waitcnt vmcnt(6)
    s_barrier
    s_lshl_b32 s49, s47, 7
    s_add_u32 m0, s55, 40960
    s_add_u32 s47, s47, 1
    buffer_load_dwordx4 v246, s[8:11], s49 offen  lds
    s_and_b32 s47, s47, 7
    s_waitcnt lgkmcnt(0)
    v_mfma_f32_16x16x32_bf16 v[182:185], v[150:153], v[150:153], v[182:185]
    v_mfma_f32_16x16x32_bf16 v[186:189], v[166:169], v[150:153], v[186:189]
    v_mfma_f32_16x16x32_bf16 v[182:185], v[154:157], v[154:157], v[182:185]
    v_mfma_f32_16x16x32_bf16 v[186:189], v[170:173], v[154:157], v[186:189]
    v_lshlrev_b32 v198, 16, v194
    v_and_b32 v194, 0xffff0000, v194
    v_add_f32 v198, v198, v194
    s_add_u32 m0, s55, 45056
    s_add_u32 s49, s49, 32768
    buffer_load_dwordx4 v246, s[8:11], s49 offen  lds
    v_lshlrev_b32 v194, 16, v195
    v_and_b32 v195, 0xffff0000, v195
    v_add_f32 v198, v198, v194
    v_add_f32 v198, v198, v195
    v_lshlrev_b32 v194, 16, v196
    v_and_b32 v196, 0xffff0000, v196
    v_add_f32 v198, v198, v194
    v_add_f32 v198, v198, v196
    v_lshlrev_b32 v194, 16, v197
    v_and_b32 v197, 0xffff0000, v197
    v_add_f32 v198, v198, v194
    v_add_f32 v198, v198, v197
    s_mul_i32 s50, s48, 196608
    s_add_u32 m0, s55, 131072
    s_add_u32 s50, s50, 1024
    buffer_load_dwordx4 v247, s[12:15], s50 offen  lds
    ds_read_b128 v[150:153], v190 offset:16384
    ds_read_b128 v[154:157], v191 offset:16384
    ds_read_b128 v[158:161], v190 offset:24576
    ds_read_b128 v[162:165], v191 offset:24576
    s_mov_b64 exec, s[82:83]
    ds_read_b128 v[166:169], v192 offset:256
    ds_read_b128 v[170:173], v192 offset:320
    ds_read_b128 v[174:177], v192 offset:384
    ds_read_b128 v[178:181], v192 offset:448
    s_mov_b64 exec, -1
    s_mul_i32 s44, s44, 1664525
    s_add_u32 s44, s44, 1013904223
    v_mov_b32 v8, s44
    s_add_u32 m0, s55, 135168
    s_add_u32 s50, s50, 98304
    buffer_load_dwordx4 v247, s[12:15], s50 offen  lds
    v_and_b32 v149, 124, v3
    v_lshlrev_b32 v9, 3, v149
    v_lshlrev_b32 v148, 5, v149
    v_and_b32 v20, 12, v3
    s_and_b32 s62, s4, 3
    s_lshl_b32 s62, s62, 8
    s_lshl_b32 s51, s3, 13
    s_add_u32 s51, s51, s62
    v_lshrrev_b32 v200, 3, v0
    v_and_b32 v201, 7, v0
    v_and_b32 v202, 6, v200
    v_xor_b32 v202, v202, v201
    s_mul_i32 s50, s48, 196608
    s_add_u32 m0, s55, 139264
    s_add_u32 s50, s50, 2048
    buffer_load_dwordx4 v247, s[12:15], s50 offen  lds
    v_lshl_add_u32 v202, v200, 6, v202
    v_lshl_add_u32 v5, v202, 4, s51
    s_lshl_b32 s51, s7, 16
    v_and_b32 v4, 0x9ff, v250
    v_and_b32 v202, 16, v0
    v_lshl_add_u32 v4, v202, 5, v4
    v_add_u32 v4, s51, v4
    s_add_u32 m0, s55, 143360
    s_add_u32 s50, s50, 98304
    buffer_load_dwordx4 v247, s[12:15], s50 offen  lds
    s_add_u32 s48, s48, 1
    s_and_b32 s48, s48, 7
    s_waitcnt vmcnt(6)
    s_barrier
    s_lshl_b32 s49, s47, 7
    s_add_u32 m0, s55, 49152
    s_add_u32 s47, s47, 1
    buffer_load_dwordx4 v246, s[8:11], s49 offen  lds
    s_and_b32 s47, s47, 7
    s_waitcnt lgkmcnt(0)
    v_mfma_f32_16x16x32_bf16 v[182:185], v[150:153], v[150:153], v[182:185]
    v_mfma_f32_16x16x32_bf16 v[186:189], v[166:169], v[150:153], v[186:189]
    v_mfma_f32_16x16x32_bf16 v[182:185], v[154:157], v[154:157], v[182:185]
    v_mfma_f32_16x16x32_bf16 v[186:189], v[170:173], v[154:157], v[186:189]
    v_mfma_f32_16x16x32_bf16 v[182:185], v[158:161], v[158:161], v[182:185]
    v_mfma_f32_16x16x32_bf16 v[186:189], v[174:177], v[158:161], v[186:189]
    s_add_u32 m0, s55, 53248
    s_add_u32 s49, s49, 32768
    buffer_load_dwordx4 v246, s[8:11], s49 offen  lds
    v_mfma_f32_16x16x32_bf16 v[182:185], v[162:165], v[162:165], v[182:185]
    v_mfma_f32_16x16x32_bf16 v[186:189], v[178:181], v[162:165], v[186:189]
    v_add_f32_dpp v198, v198, v198 quad_perm:[1,0,3,2] row_mask:0xf bank_mask:0xf
    s_nop 1
    v_add_f32_dpp v198, v198, v198 quad_perm:[2,3,0,1] row_mask:0xf bank_mask:0xf
    s_nop 1
    v_add_f32_dpp v198, v198, v198 row_half_mirror row_mask:0xf bank_mask:0xf
    ds_read_b128 v[150:153], v190 offset:32768
    ds_read_b128 v[154:157], v191 offset:32768
    s_mul_i32 s50, s48, 196608
    s_add_u32 m0, s55, 65536
    s_add_u32 s50, s50, 1024
    buffer_load_dwordx4 v247, s[12:15], s50 offen  lds
    s_mov_b64 exec, s[82:83]
    ds_read_b128 v[166:169], v192 offset:512
    ds_read_b128 v[170:173], v192 offset:576
    s_mov_b64 exec, -1
    s_cmp_eq_u32 s3, 2
    s_cselect_b32 s52, 2, 7
    s_cselect_b32 s81, 4, s3
    s_lshr_b32 s81, s81, 1
    s_lshl_b32 s81, s81, 13
    s_add_u32 s81, s81, 131072
    s_lshl_b32 s52, s52, 9
    s_add_u32 m0, s55, 69632
    s_add_u32 s50, s50, 98304
    buffer_load_dwordx4 v247, s[12:15], s50 offen  lds
    v_and_b32 v202, 2, v200
    v_mul_u32_u24 v200, s52, v200
    v_xor_b32 v201, v201, v202
    v_lshl_add_u32 v23, v201, 4, v200
    v_xor_b32 v24, 64, v23
    s_lshl_b32 s51, s6, 5
    v_xor_b32 v252, s51, v250
    s_sub_u32 s51, s81, 65536
    v_add_u32 v252, s51, v252
    s_mul_i32 s50, s48, 196608
    s_add_u32 m0, s55, 73728
    s_add_u32 s50, s50, 2048
    buffer_load_dwordx4 v247, s[12:15], s50 offen  lds
    v_xor_b32 v253, 32, v252
    v_xor_b32 v254, 64, v252
    v_xor_b32 v255, 96, v252
    s_lshl_b32 s51, s5, 5
    s_add_u32 s51, s51, s4
    s_lshl_b32 s52, s51, 1
    s_add_u32 s52, s52, s7
    s_add_u32 m0, s55, 77824
    s_add_u32 s50, s50, 98304
    buffer_load_dwordx4 v247, s[12:15], s50 offen  lds
    s_add_u32 s48, s48, 1
    s_and_b32 s48, s48, 7
    s_waitcnt vmcnt(6)
    s_barrier
    s_lshl_b32 s49, s47, 7
    s_add_u32 m0, s55, 57344
    s_add_u32 s47, s47, 1
    buffer_load_dwordx4 v246, s[8:11], s49 offen  lds
    s_and_b32 s47, s47, 7
    s_waitcnt lgkmcnt(0)
    v_mfma_f32_16x16x32_bf16 v[182:185], v[150:153], v[150:153], v[182:185]
    v_mfma_f32_16x16x32_bf16 v[186:189], v[166:169], v[150:153], v[186:189]
    v_mfma_f32_16x16x32_bf16 v[182:185], v[154:157], v[154:157], v[182:185]
    v_mfma_f32_16x16x32_bf16 v[186:189], v[170:173], v[154:157], v[186:189]
    s_add_u32 m0, s55, 61440
    s_add_u32 s49, s49, 32768
    buffer_load_dwordx4 v246, s[8:11], s49 offen  lds
    v_add_f32_dpp v198, v198, v198 row_mirror row_mask:0xf bank_mask:0xf
    s_nop 1
    v_add_f32_dpp v198, v198, v198 row_bcast:15 row_mask:0xa bank_mask:0xf
    s_nop 1
    v_add_f32_dpp v198, v198, v198 row_bcast:31 row_mask:0xc bank_mask:0xf
    ds_read_b128 v[150:153], v190 offset:40960
    ds_read_b128 v[154:157], v191 offset:40960
    s_mul_i32 s50, s48, 196608
    s_add_u32 m0, s55, 81920
    s_add_u32 s50, s50, 1024
    buffer_load_dwordx4 v247, s[12:15], s50 offen  lds
    s_mov_b64 exec, s[82:83]
    ds_read_b128 v[166:169], v192 offset:640
    ds_read_b128 v[170:173], v192 offset:704
    s_mov_b64 exec, -1
    s_lshl_b32 s70, s52, 12
    s_add_u32 s70, s70, s55
    s_add_u32 s70, s70, 4194304
    s_add_u32 m0, s55, 86016
    s_add_u32 s50, s50, 98304
    buffer_load_dwordx4 v247, s[12:15], s50 offen  lds
    s_lshl_b32 s71, s52, 5
    s_add_u32 s71, s71, s6
    s_lshl_b32 s71, s71, 2
    s_add_u32 s71, s71, 6684672
    s_lshl_b32 s52, s3, 6
    s_add_u32 s52, s52, s77
    s_lshl_b32 s72, s52, 12
    s_add_u32 s72, s72, 4194304
    s_mul_i32 s50, s48, 196608
    s_add_u32 m0, s55, 90112
    s_add_u32 s50, s50, 2048
    buffer_load_dwordx4 v247, s[12:15], s50 offen  lds
    s_lshl_b32 s73, s52, 7
    s_add_u32 s73, s73, 6684672
    s_lshr_b32 s75, s52, 1
    s_lshl_b32 s75, s75, 9
    s_add_u32 s75, s75, 7208960
    v_and_b32 v200, 31, v0
    v_lshl_add_u32 v21, s77, 5, v200
    v_and_b32 v201, 32, v0
    v_lshl_add_u32 v22, s3, 6, v201
    s_add_u32 m0, s55, 94208
    s_add_u32 s50, s50, 98304
    buffer_load_dwordx4 v247, s[12:15], s50 offen  lds
    s_add_u32 s48, s48, 1
    s_and_b32 s48, s48, 7
    s_waitcnt vmcnt(6)
    s_barrier
    s_mul_i32 s50, s48, 196608
    s_add_u32 m0, s55, 98304
    s_add_u32 s50, s50, 1024
    buffer_load_dwordx4 v247, s[12:15], s50 offen  lds
    s_waitcnt lgkmcnt(0)
    v_mfma_f32_16x16x32_bf16 v[182:185], v[150:153], v[150:153], v[182:185]
    v_mfma_f32_16x16x32_bf16 v[186:189], v[166:169], v[150:153], v[186:189]
    v_mfma_f32_16x16x32_bf16 v[182:185], v[154:157], v[154:157], v[182:185]
    v_mfma_f32_16x16x32_bf16 v[186:189], v[170:173], v[154:157], v[186:189]
    s_add_u32 m0, s55, 102400
    s_add_u32 s50, s50, 98304
    buffer_load_dwordx4 v247, s[12:15], s50 offen  lds
    v_readlane_b32 s79, v198, 63
    ds_read_b128 v[150:153], v190 offset:49152
    ds_read_b128 v[154:157], v191 offset:49152
    s_mul_i32 s50, s48, 196608
    s_add_u32 m0, s55, 106496
    s_add_u32 s50, s50, 2048
    buffer_load_dwordx4 v247, s[12:15], s50 offen  lds
    s_mov_b64 exec, s[82:83]
    ds_read_b128 v[166:169], v192 offset:768
    ds_read_b128 v[170:173], v192 offset:832
    s_mov_b64 exec, -1
    v_lshrrev_b32 v201, 1, v22
    v_lshl_add_u32 v2, v21, 10, v201
    v_add_u32 v2, s62, v2
    s_add_u32 m0, s55, 110592
    s_add_u32 s50, s50, 98304
    buffer_load_dwordx4 v247, s[12:15], s50 offen  lds
    s_add_u32 s48, s48, 1
    s_and_b32 s48, s48, 7
    v_mov_b64 v[28:29], -1
    v_mov_b64 v[30:31], -1
    v_lshl_add_u32 v18, s3, 12, v1
    v_and_b32 v200, 0x300, v1
    v_add_u32 v19, v200, v1
    s_mul_i32 s50, s48, 196608
    s_add_u32 m0, s55, 114688
    s_add_u32 s50, s50, 0
    buffer_load_dwordx4 v247, s[12:15], s50 offen  lds
    v_lshl_add_u32 v15, s3, 11, v1
    v_add_u32 v15, 131072, v15
    v_xor_b32 v14, 8192, v15
    v_lshl_add_u32 v17, s3, 8, v3
    v_add_u32 v17, 161792, v17
    v_xor_b32 v16, 1024, v17
    s_add_u32 m0, s55, 118784
    s_add_u32 s50, s50, 98304
    buffer_load_dwordx4 v247, s[12:15], s50 offen  lds
    s_add_u32 s48, s48, 1
    s_and_b32 s48, s48, 7
    s_waitcnt vmcnt(6)
    s_barrier
    ds_read_b128 v[158:161], v190 offset:57344
    ds_read_b128 v[162:165], v191 offset:57344
    s_mov_b64 exec, s[82:83]
    ds_read_b128 v[174:177], v192 offset:896
    ds_read_b128 v[178:181], v192 offset:960
    s_mov_b64 exec, -1
    s_mul_i32 s50, s48, 196608
    s_add_u32 m0, s55, 122880
    s_add_u32 s50, s50, 0
    buffer_load_dwordx4 v247, s[12:15], s50 offen  lds
    s_waitcnt lgkmcnt(4)
    v_mfma_f32_16x16x32_bf16 v[182:185], v[150:153], v[150:153], v[182:185]
    v_mfma_f32_16x16x32_bf16 v[186:189], v[166:169], v[150:153], v[186:189]
    v_mfma_f32_16x16x32_bf16 v[182:185], v[154:157], v[154:157], v[182:185]
    v_mfma_f32_16x16x32_bf16 v[186:189], v[170:173], v[154:157], v[186:189]
    s_waitcnt lgkmcnt(0)
    v_mfma_f32_16x16x32_bf16 v[182:185], v[158:161], v[158:161], v[182:185]
    v_mfma_f32_16x16x32_bf16 v[186:189], v[174:177], v[158:161], v[186:189]
    v_mfma_f32_16x16x32_bf16 v[182:185], v[162:165], v[162:165], v[182:185]
    v_mfma_f32_16x16x32_bf16 v[186:189], v[178:181], v[162:165], v[186:189]
    s_mov_b32 s58, 0x44444444
    s_mov_b32 s59, 0x44444444
    s_mov_b32 s60, 0x88888888
    s_mov_b32 s61, 0x88888888
    v_and_b32 v199, 15, v0
    v_lshl_add_u32 v199, s6, 4, v199
    v_lshlrev_b32 v199, 2, v199
    v_add_u32 v199, 156672, v199
    v_cndmask_b32 v194, v182, v183, s[82:83]
    v_cndmask_b32 v194, v194, v184, s[58:59]
    v_cndmask_b32 v194, v194, v185, s[60:61]
    v_mul_f32 v195, 0x3b000000, v186
    v_mul_f32 v194, 0x3b000000, v194
    v_fma_f32 v194, -v195, v195, v194
    v_max_f32 v194, 0, v194
    v_cvt_pk_bf16_f32 v196, v195, v194
    v_lshlrev_b32 v195, 16, v196
    v_and_b32 v194, 0xffff0000, v196
    v_add_f32 v194, 0x3727c5ac, v194
    v_cvt_pk_bf16_f32 v194, v194, v194
    v_lshlrev_b32 v194, 16, v194
    v_sqrt_f32 v194, v194
    v_fma_f32 v198, -v195, s79, v187
    v_cvt_pk_bf16_f32 v194, v194, v194
    v_lshlrev_b32 v194, 16, v194
    v_rcp_f32 v197, v194
    v_lshrrev_b32 v196, 16, v195
    v_or_b32 v196, v196, v194
    v_mul_f32 v198, v198, v197
    v_cvt_pk_bf16_f32 v198, v198, v198
    v_lshlrev_b32 v198, 16, v198
    s_mov_b32 s58, 0x00f0000f
    s_mov_b32 s59, 0xf0000f00
    s_mov_b64 exec, s[58:59]
    ds_write2_b32 v199, v195, v197 offset0:0 offset1:64
    ds_write2_b32 v199, v198, v196 offset0:128 offset1:192
    s_mov_b64 exec, -1
    s_add_u32 m0, s55, 126976
    s_add_u32 s50, s50, 98304
    buffer_load_dwordx4 v247, s[12:15], s50 offen  lds
    s_add_u32 s48, s48, 1
    s_and_b32 s48, s48, 7
    s_waitcnt lgkmcnt(0)
    s_waitcnt vmcnt(4)
    s_barrier
    s_mul_i32 s50, s48, 196608
    s_add_u32 m0, s55, 131072
    s_add_u32 s50, s50, 0
    buffer_load_dwordx4 v247, s[12:15], s50 offen  lds
    v_and_b32 v193, 15, v0
    v_lshlrev_b32 v193, 2, v193
    v_add_u32 v193, 156672, v193
    ds_read2_b32 v[230:231], v193 offset0:0 offset1:16
    ds_read2_b32 v[232:233], v193 offset0:32 offset1:48
    ds_read2_b32 v[234:235], v193 offset0:64 offset1:80
    ds_read2_b32 v[236:237], v193 offset0:96 offset1:112
    s_add_u32 m0, s55, 135168
    s_add_u32 s50, s50, 98304
    buffer_load_dwordx4 v247, s[12:15], s50 offen  lds
    s_add_u32 s48, s48, 1
    s_and_b32 s48, s48, 7
    s_mul_i32 s50, s48, 196608
    s_add_u32 m0, s55, 139264
    s_add_u32 s50, s50, 0
    buffer_load_dwordx4 v247, s[12:15], s50 offen  lds
    s_add_u32 m0, s55, 143360
    s_add_u32 s50, s50, 98304
    buffer_load_dwordx4 v247, s[12:15], s50 offen  lds
    s_add_u32 s48, s48, 1
    s_and_b32 s48, s48, 7
    s_mul_i32 s50, s48, 196608
    s_add_u32 m0, s55, 65536
    s_add_u32 s50, s50, 0
    buffer_load_dwordx4 v247, s[12:15], s50 offen  lds
    s_add_u32 m0, s55, 69632
    s_add_u32 s50, s50, 98304
    buffer_load_dwordx4 v247, s[12:15], s50 offen  lds
    s_add_u32 s48, s48, 1
    s_and_b32 s48, s48, 7
    s_mul_i32 s50, s48, 196608
    s_add_u32 m0, s55, 73728
    s_add_u32 s50, s50, 0
    buffer_load_dwordx4 v247, s[12:15], s50 offen  lds
    s_add_u32 m0, s55, 77824
    s_add_u32 s50, s50, 98304
    buffer_load_dwordx4 v247, s[12:15], s50 offen  lds
    s_add_u32 s48, s48, 1
    s_and_b32 s48, s48, 7
    s_mul_i32 s50, s48, 196608
    s_add_u32 m0, s55, 81920
    s_add_u32 s50, s50, 0
    buffer_load_dwordx4 v247, s[12:15], s50 offen  lds
    s_add_u32 m0, s55, 86016
    s_add_u32 s50, s50, 98304
    buffer_load_dwordx4 v247, s[12:15], s50 offen  lds
    s_add_u32 s48, s48, 1
    s_and_b32 s48, s48, 7
    s_mul_i32 s50, s48, 196608
    s_add_u32 m0, s55, 90112
    s_add_u32 s50, s50, 0
    buffer_load_dwordx4 v247, s[12:15], s50 offen  lds
    s_add_u32 m0, s55, 94208
    s_add_u32 s50, s50, 98304
    buffer_load_dwordx4 v247, s[12:15], s50 offen  lds
    s_add_u32 s48, s48, 1
    s_and_b32 s48, s48, 7
    s_waitcnt lgkmcnt(0)
    s_setprio 0
    ds_read_b128 v[150:153], v248 offset:0
    ds_read_b128 v[154:157], v248 offset:2048
    ds_read_b128 v[158:161], v248 offset:4096
    ds_read_b128 v[162:165], v248 offset:6144
    ds_read_b128 v[166:169], v249 offset:0
    ds_read_b128 v[170:173], v249 offset:2048
    ds_read_b128 v[174:177], v249 offset:4096
    ds_read_b128 v[178:181], v249 offset:6144
    ds_read_b128 v[182:185], v248 offset:8192
    ds_read_b128 v[186:189], v248 offset:10240
    ds_read_b128 v[190:193], v248 offset:12288
    ds_read_b128 v[194:197], v248 offset:14336
    ds_read_b128 v[32:35], v249 offset:8192
    ds_read_b128 v[36:39], v249 offset:10240
    ds_read_b128 v[40:43], v249 offset:12288
    ds_read_b128 v[44:47], v249 offset:14336
    ds_read_b128 v[48:51], v248 offset:16384
    ds_read_b128 v[52:55], v248 offset:18432
    ds_read_b128 v[56:59], v248 offset:20480
    ds_read_b128 v[60:63], v248 offset:22528
    v_mul_f32 v234, 0x3eb8aa3b, v234
    v_mul_f32 v235, 0x3eb8aa3b, v235
    v_mul_f32 v236, 0x3eb8aa3b, v236
    v_mul_f32 v237, 0x3eb8aa3b, v237
    s_waitcnt lgkmcnt(0)
    s_waitcnt vmcnt(8)
    s_barrier
    ds_read_b64_tr_b16 v[198:199], v251 offset:16384
    ds_read_b64_tr_b16 v[200:201], v251 offset:16896
    ds_read_b64_tr_b16 v[202:203], v251 offset:20480
    ds_read_b64_tr_b16 v[204:205], v251 offset:20992
    s_waitcnt lgkmcnt(2)
    v_mfma_f32_16x16x32_bf16 v[226:229], v[198:201], v[242:245], 0
    ds_read_b64_tr_b16 v[206:207], v251 offset:24576
    ds_read_b64_tr_b16 v[208:209], v251 offset:25088
    v_mfma_f32_16x16x32_bf16 v[210:213], v[198:201], v[150:153], 0
    v_mfma_f32_16x16x32_bf16 v[214:217], v[198:201], v[154:157], 0
    v_mfma_f32_16x16x32_bf16 v[218:221], v[198:201], v[158:161], 0
    v_mfma_f32_16x16x32_bf16 v[222:225], v[198:201], v[162:165], 0
    s_waitcnt lgkmcnt(2)
    v_mfma_f32_16x16x32_bf16 v[226:229], v[202:205], v[242:245], v[226:229]
    ds_read_b64_tr_b16 v[198:199], v251 offset:28672
    ds_read_b64_tr_b16 v[200:201], v251 offset:29184
    v_mfma_f32_16x16x32_bf16 v[210:213], v[202:205], v[166:169], v[210:213]
    ds_read_b128 v[150:153], v249 offset:16384
    v_mfma_f32_16x16x32_bf16 v[214:217], v[202:205], v[170:173], v[214:217]
    ds_read_b128 v[154:157], v249 offset:18432
    v_mfma_f32_16x16x32_bf16 v[218:221], v[202:205], v[174:177], v[218:221]
    ds_read_b128 v[158:161], v249 offset:20480
    v_mfma_f32_16x16x32_bf16 v[222:225], v[202:205], v[178:181], v[222:225]
    s_waitcnt lgkmcnt(5)
    v_mfma_f32_16x16x32_bf16 v[226:229], v[206:209], v[242:245], v[226:229]
    ds_read_b64_tr_b16 v[202:203], v251 offset:32768
    ds_read_b64_tr_b16 v[204:205], v251 offset:33280
    v_mfma_f32_16x16x32_bf16 v[210:213], v[206:209], v[182:185], v[210:213]
    ds_read_b128 v[162:165], v249 offset:22528
    v_mfma_f32_16x16x32_bf16 v[214:217], v[206:209], v[186:189], v[214:217]
    ds_read_b128 v[166:169], v248 offset:24576
    v_mfma_f32_16x16x32_bf16 v[218:221], v[206:209], v[190:193], v[218:221]
    ds_read_b128 v[170:173], v248 offset:26624
    v_mfma_f32_16x16x32_bf16 v[222:225], v[206:209], v[194:197], v[222:225]
    s_waitcnt lgkmcnt(8)
    v_mfma_f32_16x16x32_bf16 v[226:229], v[198:201], v[242:245], v[226:229]
    ds_read_b64_tr_b16 v[206:207], v251 offset:36864
    ds_read_b64_tr_b16 v[208:209], v251 offset:37376
    v_mfma_f32_16x16x32_bf16 v[210:213], v[198:201], v[32:35], v[210:213]
    ds_read_b128 v[174:177], v248 offset:28672
    v_mfma_f32_16x16x32_bf16 v[214:217], v[198:201], v[36:39], v[214:217]
    ds_read_b128 v[178:181], v248 offset:30720
    v_mfma_f32_16x16x32_bf16 v[218:221], v[198:201], v[40:43], v[218:221]
    ds_read_b128 v[182:185], v249 offset:24576
    v_mfma_f32_16x16x32_bf16 v[222:225], v[198:201], v[44:47], v[222:225]
    s_waitcnt lgkmcnt(8)
    v_mfma_f32_16x16x32_bf16 v[226:229], v[202:205], v[242:245], v[226:229]
    ds_read_b64_tr_b16 v[198:199], v251 offset:40960
    ds_read_b64_tr_b16 v[200:201], v251 offset:41472
    v_mfma_f32_16x16x32_bf16 v[210:213], v[202:205], v[48:51], v[210:213]
    ds_read_b128 v[186:189], v249 offset:26624
    v_mfma_f32_16x16x32_bf16 v[214:217], v[202:205], v[52:55], v[214:217]
    ds_read_b128 v[190:193], v249 offset:28672
    v_mfma_f32_16x16x32_bf16 v[218:221], v[202:205], v[56:59], v[218:221]
    ds_read_b128 v[194:197], v249 offset:30720
    v_mfma_f32_16x16x32_bf16 v[222:225], v[202:205], v[60:63], v[222:225]
    s_waitcnt lgkmcnt(8)
    v_mfma_f32_16x16x32_bf16 v[226:229], v[206:209], v[242:245], v[226:229]
    ds_read_b64_tr_b16 v[202:203], v251 offset:45056
    ds_read_b64_tr_b16 v[204:205], v251 offset:45568
    v_mfma_f32_16x16x32_bf16 v[210:213], v[206:209], v[150:153], v[210:213]
    ds_read_b128 v[32:35], v248 offset:32768
    v_mfma_f32_16x16x32_bf16 v[214:217], v[206:209], v[154:157], v[214:217]
    ds_read_b128 v[36:39], v248 offset:34816
    v_mfma_f32_16x16x32_bf16 v[218:221], v[206:209], v[158:161], v[218:221]
    ds_read_b128 v[40:43], v248 offset:36864
    v_mfma_f32_16x16x32_bf16 v[222:225], v[206:209], v[162:165], v[222:225]
    s_waitcnt vmcnt(0)
    s_barrier
    s_waitcnt lgkmcnt(8)
    v_mfma_f32_16x16x32_bf16 v[226:229], v[198:201], v[242:245], v[226:229]
    ds_read_b64_tr_b16 v[206:207], v250 offset:0
    ds_read_b64_tr_b16 v[208:209], v250 offset:512
    v_mfma_f32_16x16x32_bf16 v[210:213], v[198:201], v[166:169], v[210:213]
    ds_read_b128 v[44:47], v248 offset:38912
    v_mfma_f32_16x16x32_bf16 v[214:217], v[198:201], v[170:173], v[214:217]
    ds_read_b128 v[48:51], v249 offset:32768
    v_mfma_f32_16x16x32_bf16 v[218:221], v[198:201], v[174:177], v[218:221]
    ds_read_b128 v[52:55], v249 offset:34816
    v_mfma_f32_16x16x32_bf16 v[222:225], v[198:201], v[178:181], v[222:225]
    s_waitcnt lgkmcnt(8)
    v_mfma_f32_16x16x32_bf16 v[226:229], v[202:205], v[242:245], v[226:229]
    ds_read_b64_tr_b16 v[198:199], v250 offset:4096
    ds_read_b64_tr_b16 v[200:201], v250 offset:4608
    v_mfma_f32_16x16x32_bf16 v[210:213], v[202:205], v[182:185], v[210:213]
    ds_read_b128 v[56:59], v249 offset:36864
    v_mfma_f32_16x16x32_bf16 v[214:217], v[202:205], v[186:189], v[214:217]
    ds_read_b128 v[60:63], v249 offset:38912
    v_mfma_f32_16x16x32_bf16 v[218:221], v[202:205], v[190:193], v[218:221]
    ds_read_b128 v[150:153], v248 offset:40960
    v_mfma_f32_16x16x32_bf16 v[222:225], v[202:205], v[194:197], v[222:225]
    s_waitcnt lgkmcnt(7)
    v_mfma_f32_16x16x32_bf16 v[226:229], v[206:209], v[242:245], v[226:229]
    ds_read_b64_tr_b16 v[202:203], v250 offset:8192
    ds_read_b64_tr_b16 v[204:205], v250 offset:8704
    v_mfma_f32_16x16x32_bf16 v[210:213], v[206:209], v[32:35], v[210:213]
    ds_read_b128 v[154:157], v248 offset:43008
    v_mfma_f32_16x16x32_bf16 v[214:217], v[206:209], v[36:39], v[214:217]
    ds_read_b128 v[158:161], v248 offset:45056
    v_mfma_f32_16x16x32_bf16 v[218:221], v[206:209], v[40:43], v[218:221]
    ds_read_b128 v[162:165], v248 offset:47104
    v_mfma_f32_16x16x32_bf16 v[222:225], v[206:209], v[44:47], v[222:225]
    s_waitcnt lgkmcnt(6)
    v_mfma_f32_16x16x32_bf16 v[226:229], v[198:201], v[242:245], v[226:229]
    ds_read_b64_tr_b16 v[206:207], v250 offset:12288
    ds_read_b64_tr_b16 v[208:209], v250 offset:12800
    v_mfma_f32_16x16x32_bf16 v[210:213], v[198:201], v[48:51], v[210:213]
    ds_read_b128 v[166:169], v249 offset:40960
    v_mfma_f32_16x16x32_bf16 v[214:217], v[198:201], v[52:55], v[214:217]
    ds_read_b128 v[170:173], v249 offset:43008
    v_mfma_f32_16x16x32_bf16 v[218:221], v[198:201], v[56:59], v[218:221]
    ds_read_b128 v[174:177], v249 offset:45056
    v_mfma_f32_16x16x32_bf16 v[222:225], v[198:201], v[60:63], v[222:225]
    ds_read_b128 v[178:181], v249 offset:47104
    s_waitcnt lgkmcnt(6)
    v_mfma_f32_16x16x32_bf16 v[226:229], v[202:205], v[242:245], v[226:229]
    ds_read_b64_tr_b16 v[198:199], v250 offset:16384
    ds_read_b64_tr_b16 v[200:201], v250 offset:16896
    v_mfma_f32_16x16x32_bf16 v[210:213], v[202:205], v[150:153], v[210:213]
    ds_read_b128 v[182:185], v248 offset:49152
    v_mfma_f32_16x16x32_bf16 v[214:217], v[202:205], v[154:157], v[214:217]
    ds_read_b128 v[186:189], v248 offset:51200
    v_mfma_f32_16x16x32_bf16 v[218:221], v[202:205], v[158:161], v[218:221]
    ds_read_b128 v[190:193], v248 offset:53248
    v_mfma_f32_16x16x32_bf16 v[222:225], v[202:205], v[162:165], v[222:225]
    ds_read_b128 v[194:197], v248 offset:55296
    v_mov_b64 v[32:33], 0
    v_mov_b64 v[34:35], 0
    v_mov_b64 v[36:37], 0
    s_waitcnt lgkmcnt(6)
    v_mfma_f32_16x16x32_bf16 v[226:229], v[206:209], v[242:245], v[226:229]
    ds_read_b64_tr_b16 v[202:203], v250 offset:20480
    ds_read_b64_tr_b16 v[204:205], v250 offset:20992
    v_mfma_f32_16x16x32_bf16 v[210:213], v[206:209], v[166:169], v[210:213]
    ds_read_b128 v[150:153], v249 offset:49152
    v_mfma_f32_16x16x32_bf16 v[214:217], v[206:209], v[170:173], v[214:217]
    ds_read_b128 v[154:157], v249 offset:51200
    v_mfma_f32_16x16x32_bf16 v[218:221], v[206:209], v[174:177], v[218:221]
    ds_read_b128 v[158:161], v249 offset:53248
    v_mfma_f32_16x16x32_bf16 v[222:225], v[206:209], v[178:181], v[222:225]
    ds_read_b128 v[162:165], v249 offset:55296
    v_mov_b64 v[38:39], 0
    v_mov_b64 v[40:41], 0
    v_mov_b64 v[42:43], 0
    s_waitcnt lgkmcnt(6)
    v_mfma_f32_16x16x32_bf16 v[226:229], v[198:201], v[242:245], v[226:229]
    ds_read_b64_tr_b16 v[206:207], v250 offset:24576
    ds_read_b64_tr_b16 v[208:209], v250 offset:25088
    v_mfma_f32_16x16x32_bf16 v[210:213], v[198:201], v[182:185], v[210:213]
    ds_read_b128 v[166:169], v248 offset:57344
    v_mfma_f32_16x16x32_bf16 v[214:217], v[198:201], v[186:189], v[214:217]
    ds_read_b128 v[170:173], v248 offset:59392
    v_mfma_f32_16x16x32_bf16 v[218:221], v[198:201], v[190:193], v[218:221]
    ds_read_b128 v[174:177], v248 offset:61440
    v_mfma_f32_16x16x32_bf16 v[222:225], v[198:201], v[194:197], v[222:225]
    ds_read_b128 v[178:181], v248 offset:63488
    v_mov_b64 v[44:45], 0
    v_mov_b64 v[46:47], 0
    v_mov_b64 v[48:49], 0
    s_waitcnt lgkmcnt(6)
    v_mfma_f32_16x16x32_bf16 v[226:229], v[202:205], v[242:245], v[226:229]
    ds_read_b64_tr_b16 v[198:199], v250 offset:28672
    ds_read_b64_tr_b16 v[200:201], v250 offset:29184
    v_mfma_f32_16x16x32_bf16 v[210:213], v[202:205], v[150:153], v[210:213]
    ds_read_b128 v[182:185], v249 offset:57344
    v_mfma_f32_16x16x32_bf16 v[214:217], v[202:205], v[154:157], v[214:217]
    ds_read_b128 v[186:189], v249 offset:59392
    v_mfma_f32_16x16x32_bf16 v[218:221], v[202:205], v[158:161], v[218:221]
    ds_read_b128 v[190:193], v249 offset:61440
    v_mfma_f32_16x16x32_bf16 v[222:225], v[202:205], v[162:165], v[222:225]
    ds_read_b128 v[194:197], v249 offset:63488
    v_mov_b64 v[50:51], 0
    v_mov_b64 v[52:53], 0
    v_mov_b64 v[54:55], 0
    s_waitcnt lgkmcnt(6)
    v_mfma_f32_16x16x32_bf16 v[226:229], v[206:209], v[242:245], v[226:229]
    v_mfma_f32_16x16x32_bf16 v[210:213], v[206:209], v[166:169], v[210:213]
    v_mfma_f32_16x16x32_bf16 v[214:217], v[206:209], v[170:173], v[214:217]
    v_mfma_f32_16x16x32_bf16 v[218:221], v[206:209], v[174:177], v[218:221]
    v_mfma_f32_16x16x32_bf16 v[222:225], v[206:209], v[178:181], v[222:225]
    v_mov_b64 v[56:57], 0
    v_mov_b64 v[58:59], 0
    v_mov_b64 v[60:61], 0
    s_waitcnt lgkmcnt(0)
    v_mfma_f32_16x16x32_bf16 v[226:229], v[198:201], v[242:245], v[226:229]
    v_mfma_f32_16x16x32_bf16 v[210:213], v[198:201], v[182:185], v[210:213]
    v_mfma_f32_16x16x32_bf16 v[214:217], v[198:201], v[186:189], v[214:217]
    v_mfma_f32_16x16x32_bf16 v[218:221], v[198:201], v[190:193], v[218:221]
    v_mfma_f32_16x16x32_bf16 v[222:225], v[198:201], v[194:197], v[222:225]
    v_mov_b64 v[62:63], 0
    v_xor_b32 v26, 4096, v25
    s_lshl_b32 s49, s6, 2
    s_add_u32 s49, s49, 157760
    v_mov_b32 v27, s49
    v_pk_fma_f32 v[210:211], v[230:231], v[226:227], v[210:211] op_sel:[0,0,0] op_sel_hi:[0,1,1] neg_lo:[1,0,0] neg_hi:[1,0,0]
    v_pk_fma_f32 v[212:213], v[230:231], v[228:229], v[212:213] op_sel:[0,0,0] op_sel_hi:[0,1,1] neg_lo:[1,0,0] neg_hi:[1,0,0]
    v_pk_fma_f32 v[214:215], v[230:231], v[226:227], v[214:215] op_sel:[1,0,0] op_sel_hi:[1,1,1] neg_lo:[1,0,0] neg_hi:[1,0,0]
    v_pk_fma_f32 v[216:217], v[230:231], v[228:229], v[216:217] op_sel:[1,0,0] op_sel_hi:[1,1,1] neg_lo:[1,0,0] neg_hi:[1,0,0]
    v_pk_fma_f32 v[218:219], v[232:233], v[226:227], v[218:219] op_sel:[0,0,0] op_sel_hi:[0,1,1] neg_lo:[1,0,0] neg_hi:[1,0,0]
    v_pk_fma_f32 v[220:221], v[232:233], v[228:229], v[220:221] op_sel:[0,0,0] op_sel_hi:[0,1,1] neg_lo:[1,0,0] neg_hi:[1,0,0]
    v_pk_fma_f32 v[222:223], v[232:233], v[226:227], v[222:223] op_sel:[1,0,0] op_sel_hi:[1,1,1] neg_lo:[1,0,0] neg_hi:[1,0,0]
    v_pk_fma_f32 v[224:225], v[232:233], v[228:229], v[224:225] op_sel:[1,0,0] op_sel_hi:[1,1,1] neg_lo:[1,0,0] neg_hi:[1,0,0]
    v_pk_mul_f32 v[210:211], v[234:235], v[210:211] op_sel:[0,0] op_sel_hi:[0,1]
    v_pk_mul_f32 v[212:213], v[234:235], v[212:213] op_sel:[0,0] op_sel_hi:[0,1]
    v_pk_mul_f32 v[214:215], v[234:235], v[214:215] op_sel:[1,0] op_sel_hi:[1,1]
    v_pk_mul_f32 v[216:217], v[234:235], v[216:217] op_sel:[1,0] op_sel_hi:[1,1]
    v_pk_mul_f32 v[218:219], v[236:237], v[218:219] op_sel:[0,0] op_sel_hi:[0,1]
    v_pk_mul_f32 v[220:221], v[236:237], v[220:221] op_sel:[0,0] op_sel_hi:[0,1]
    v_pk_mul_f32 v[222:223], v[236:237], v[222:223] op_sel:[1,0] op_sel_hi:[1,1]
    v_pk_mul_f32 v[224:225], v[236:237], v[224:225] op_sel:[1,0] op_sel_hi:[1,1]
    v_cvt_pk_bf16_f32 v64, v210, v211
    v_cvt_pk_bf16_f32 v65, v212, v213
    v_cvt_pk_bf16_f32 v66, v214, v215
    v_cvt_pk_bf16_f32 v67, v216, v217
    v_cvt_pk_bf16_f32 v68, v218, v219
    v_cvt_pk_bf16_f32 v69, v220, v221
    v_cvt_pk_bf16_f32 v70, v222, v223
    v_cvt_pk_bf16_f32 v71, v224, v225
    v_permlane16_swap_b32 v64, v66
    v_permlane16_swap_b32 v65, v67
    v_permlane16_swap_b32 v68, v70
    v_permlane16_swap_b32 v69, v71
    ds_write_b128 v26, v[68:71]
    ds_write_b128 v26, v[64:67] offset:8192
    s_waitcnt lgkmcnt(0)
    s_barrier
    ds_read_b32 v27, v27
    ds_read_b128 v[72:75], v25
    s_mov_b64 exec, s[56:57]
    ds_read_b128 v[76:79], v25 offset:8192
    ds_read_b128 v[80:83], v25 offset:8448
    s_mov_b64 exec, -1
    s_setprio 2
    s_waitcnt lgkmcnt(3)
    v_readfirstlane_b32 s78, v27
    s_nop 0
    s_and_b32 s49, s78, 0xf
    s_cbranch_scc1 L_att
    buffer_load_dwordx4 v[84:87], v11, s[16:19], s53 offen sc1
    s_mov_b64 exec, s[56:57]
    buffer_load_dwordx4 v[88:91], v11, s[16:19], s53 offen offset:1024 sc1
    buffer_load_dwordx4 v[92:95], v11, s[16:19], s53 offen offset:1280 sc1
    s_mov_b64 exec, -1
    buffer_load_dwordx4 v[96:99], v12, s[16:19], s53 offen sc1
    s_mov_b64 exec, s[56:57]
    buffer_load_dwordx4 v[100:103], v12, s[16:19], s53 offen offset:1024 sc1
    buffer_load_dwordx4 v[104:107], v12, s[16:19], s53 offen offset:1280 sc1
    s_mov_b64 exec, -1
    buffer_load_dwordx4 v[108:111], v13, s[16:19], s53 offen sc1
    s_mov_b64 exec, s[56:57]
    buffer_load_dwordx4 v[112:115], v13, s[16:19], s53 offen offset:1024 sc1
    buffer_load_dwordx4 v[116:119], v13, s[16:19], s53 offen offset:1280 sc1
    s_mov_b64 exec, -1
    s_branch L_att
L_compute:
    s_load_dwordx2 s[16:17], s[0:1], 80
    s_load_dwordx2 s[20:21], s[0:1], 16
    s_load_dwordx2 s[24:25], s[0:1], 64
    s_load_dwordx2 s[28:29], s[0:1], 40
    s_load_dwordx2 s[32:33], s[0:1], 48
    s_load_dwordx2 s[36:37], s[0:1], 56
    v_and_b32 v151, 15, v0
    v_lshrrev_b32 v153, 1, v151
    v_xor_b32 v153, v153, v152
    v_lshlrev_b32 v248, 7, v151
    v_lshl_add_u32 v248, v153, 4, v248
    v_xor_b32 v249, 64, v248
    v_bfe_u32 v150, v0, 2, 2
    v_bfe_u32 v153, v0, 3, 2
    v_and_b32 v154, 3, v0
    v_xor_b32 v153, s6, v153
    v_lshl_add_u32 v250, v152, 3, v150
    v_lshl_add_u32 v250, v250, 2, v153
    v_lshl_add_u32 v250, v250, 2, v154
    v_lshlrev_b32 v250, 3, v250
    v_add_u32 v250, 65536, v250
    v_add_u32 v251, 32768, v250
    v_mov_b32 v242, 0x3f803f80
    v_mov_b32 v243, v242
    v_mov_b64 v[244:245], v[242:243]
    s_mov_b32 s22, 524288
    s_mov_b32 s23, 0x20000
    s_mov_b32 s26, 2097152
    s_mov_b32 s27, 0x20000
    s_mov_b32 s30, 1835008
    s_mov_b32 s31, 0x20000
    s_mov_b32 s38, 1835008
    s_mov_b32 s39, 0x20000
    s_mov_b32 s56, 0xffff
    s_mov_b32 s57, 0xffff
    s_lshl_b32 s45, s3, 10
    v_lshlrev_b32 v3, 2, v0
    v_mov_b32 v7, 0
    v_mov_b32 v6, 0xdddddddd
    v_and_b32 v238, 11, v0
    v_cmp_eq_u32 vcc, 0, v238
    v_add_u32 v25, s45, v1
    v_add_u32 v25, 98304, v25
    v_cndmask_b32 v76, 0, v242, vcc
    v_mov_b32 v77, v76
    v_mov_b64 v[78:79], v[76:77]
    v_mov_b64 v[80:81], v[76:77]
    v_mov_b64 v[82:83], v[76:77]
    v_mov_b64 v[88:89], v[76:77]
    v_mov_b64 v[90:91], v[76:77]
    v_mov_b64 v[92:93], v[76:77]
    v_mov_b64 v[94:95], v[76:77]
    v_mov_b64 v[100:101], v[76:77]
    v_mov_b64 v[102:103], v[76:77]
    v_mov_b64 v[104:105], v[76:77]
    v_mov_b64 v[106:107], v[76:77]
    v_mov_b64 v[112:113], v[76:77]
    v_mov_b64 v[114:115], v[76:77]
    v_mov_b64 v[116:117], v[76:77]
    v_mov_b64 v[118:119], v[76:77]
    v_mov_b64 v[124:125], v[76:77]
    v_mov_b64 v[126:127], v[76:77]
    v_mov_b64 v[128:129], v[76:77]
    v_mov_b64 v[130:131], v[76:77]
    v_mov_b64 v[136:137], v[76:77]
    v_mov_b64 v[138:139], v[76:77]
    v_mov_b64 v[140:141], v[76:77]
    v_mov_b64 v[142:143], v[76:77]
    s_lshl_b32 s51, s5, 8
    s_add_u32 s51, s51, s3
    v_lshl_add_u32 v238, s51, 11, v1
    s_add_u32 s51, s4, 0
    s_and_b32 s51, s51, 3
    v_lshl_add_u32 v10, s51, 14, v238
    s_add_u32 s51, s4, 1
    s_and_b32 s51, s51, 3
    v_lshl_add_u32 v11, s51, 14, v238
    s_add_u32 s51, s4, 2
    s_and_b32 s51, s51, 3
    v_lshl_add_u32 v12, s51, 14, v238
    s_add_u32 s51, s4, 3
    s_and_b32 s51, s51, 3
    v_lshl_add_u32 v13, s51, 14, v238
    s_lshr_b32 s51, s4, 2
    s_lshl_b32 s53, s51, 16
    s_lshl_b32 s77, s5, 3
    s_add_u32 s77, s77, s51
    s_lshl_b32 s51, s5, 2
    s_add_u32 s51, s51, s6
    s_lshl_b32 s74, s51, 12
    s_add_u32 s74, s74, 6553600
    s_lshl_b32 s76, s51, 7
    s_add_u32 s76, s76, 6299648
    v_and_b32 v149, 124, v3
    v_lshlrev_b32 v9, 3, v149
    v_lshlrev_b32 v148, 5, v149
    v_and_b32 v20, 12, v3
    s_and_b32 s62, s4, 3
    s_lshl_b32 s62, s62, 8
    s_lshl_b32 s51, s3, 13
    s_add_u32 s51, s51, s62
    v_lshrrev_b32 v238, 3, v0
    v_and_b32 v239, 7, v0
    v_and_b32 v240, 6, v238
    v_xor_b32 v240, v240, v239
    v_lshl_add_u32 v240, v238, 6, v240
    v_lshl_add_u32 v5, v240, 4, s51
    s_lshl_b32 s51, s7, 16
    v_and_b32 v4, 0x9ff, v250
    v_and_b32 v240, 16, v0
    v_lshl_add_u32 v4, v240, 5, v4
    v_add_u32 v4, s51, v4
    s_cmp_eq_u32 s3, 2
    s_cselect_b32 s52, 2, 7
    s_cselect_b32 s81, 4, s3
    s_lshr_b32 s81, s81, 1
    s_lshl_b32 s81, s81, 13
    s_add_u32 s81, s81, 131072
    s_lshl_b32 s52, s52, 9
    v_and_b32 v240, 2, v238
    v_mul_u32_u24 v238, s52, v238
    v_xor_b32 v239, v239, v240
    v_lshl_add_u32 v23, v239, 4, v238
    v_xor_b32 v24, 64, v23
    s_lshl_b32 s51, s6, 5
    s_waitcnt lgkmcnt(0)
    s_mov_b32 s82, 0x22222222
    s_mov_b32 s83, 0x22222222
    s_barrier
    ds_read_b64_tr_b16 v[150:151], v250 offset:0
    ds_read_b64_tr_b16 v[152:153], v250 offset:512
    ds_read_b128 v[158:161], v248 offset:0
    ds_read_b64_tr_b16 v[154:155], v250 offset:8192
    ds_read_b64_tr_b16 v[156:157], v250 offset:8704
    ds_read_b128 v[162:165], v248 offset:2048
    ds_read_b128 v[166:169], v248 offset:4096
    ds_read_b128 v[170:173], v248 offset:6144
    ds_read_b64_tr_b16 v[174:175], v250 offset:4096
    ds_read_b64_tr_b16 v[176:177], v250 offset:4608
    ds_read_b128 v[182:185], v249 offset:0
    ds_read_b64_tr_b16 v[178:179], v250 offset:12288
    ds_read_b64_tr_b16 v[180:181], v250 offset:12800
    ds_read_b128 v[186:189], v249 offset:2048
    ds_read_b128 v[190:193], v249 offset:4096
    ds_read_b128 v[194:197], v249 offset:6144
    s_waitcnt lgkmcnt(14)
    v_mfma_f32_16x16x32_bf16 v[230:233], v[150:153], v[242:245], 0
    v_xor_b32 v252, s51, v250
    s_sub_u32 s51, s81, 65536
    s_waitcnt lgkmcnt(13)
    v_mfma_f32_16x16x32_bf16 v[198:201], v[150:153], v[158:161], 0
    v_add_u32 v252, s51, v252
    v_xor_b32 v253, 32, v252
    s_waitcnt lgkmcnt(11)
    v_mfma_f32_16x16x32_bf16 v[234:237], v[242:245], v[154:157], 0
    v_xor_b32 v254, 64, v252
    v_xor_b32 v255, 96, v252
    v_mfma_f32_16x16x32_bf16 v[214:217], v[158:161], v[154:157], 0
    s_lshl_b32 s51, s5, 5
    s_add_u32 s51, s51, s4
    s_waitcnt lgkmcnt(10)
    v_mfma_f32_16x16x32_bf16 v[202:205], v[150:153], v[162:165], 0
    s_lshl_b32 s52, s51, 1
    s_add_u32 s52, s52, s7
    v_mfma_f32_16x16x32_bf16 v[218:221], v[162:165], v[154:157], 0
    s_lshl_b32 s70, s52, 12
    s_add_u32 s70, s70, s55
    s_waitcnt lgkmcnt(9)
    v_mfma_f32_16x16x32_bf16 v[206:209], v[150:153], v[166:169], 0
    s_add_u32 s70, s70, 4194304
    s_lshl_b32 s71, s52, 5
    v_mfma_f32_16x16x32_bf16 v[222:225], v[166:169], v[154:157], 0
    s_add_u32 s71, s71, s6
    s_lshl_b32 s71, s71, 2
    s_waitcnt lgkmcnt(8)
    v_mfma_f32_16x16x32_bf16 v[210:213], v[150:153], v[170:173], 0
    s_add_u32 s71, s71, 6684672
    s_lshl_b32 s52, s3, 6
    v_mfma_f32_16x16x32_bf16 v[226:229], v[170:173], v[154:157], 0
    s_add_u32 s52, s52, s77
    s_lshl_b32 s72, s52, 12
    s_waitcnt lgkmcnt(0)
    s_barrier
    ds_read_b64_tr_b16 v[32:33], v250 offset:16384
    ds_read_b64_tr_b16 v[34:35], v250 offset:16896
    ds_read_b128 v[40:43], v248 offset:8192
    ds_read_b64_tr_b16 v[36:37], v250 offset:24576
    ds_read_b64_tr_b16 v[38:39], v250 offset:25088
    v_mfma_f32_16x16x32_bf16 v[230:233], v[174:177], v[242:245], v[230:233]
    s_add_u32 s72, s72, 4194304
    ds_read_b128 v[44:47], v248 offset:10240
    v_mfma_f32_16x16x32_bf16 v[198:201], v[174:177], v[182:185], v[198:201]
    s_lshl_b32 s73, s52, 7
    ds_read_b128 v[48:51], v248 offset:12288
    v_mfma_f32_16x16x32_bf16 v[234:237], v[242:245], v[178:181], v[234:237]
    s_add_u32 s73, s73, 6684672
    ds_read_b128 v[52:55], v248 offset:14336
    v_mfma_f32_16x16x32_bf16 v[214:217], v[182:185], v[178:181], v[214:217]
    s_lshr_b32 s75, s52, 1
    ds_read_b64_tr_b16 v[150:151], v250 offset:20480
    ds_read_b64_tr_b16 v[152:153], v250 offset:20992
    v_mfma_f32_16x16x32_bf16 v[202:205], v[174:177], v[186:189], v[202:205]
    s_lshl_b32 s75, s75, 9
    ds_read_b128 v[158:161], v249 offset:8192
    v_mfma_f32_16x16x32_bf16 v[218:221], v[186:189], v[178:181], v[218:221]
    s_add_u32 s75, s75, 7208960
    ds_read_b64_tr_b16 v[154:155], v250 offset:28672
    ds_read_b64_tr_b16 v[156:157], v250 offset:29184
    v_mfma_f32_16x16x32_bf16 v[206:209], v[174:177], v[190:193], v[206:209]
    v_and_b32 v238, 31, v0
    ds_read_b128 v[162:165], v249 offset:10240
    v_mfma_f32_16x16x32_bf16 v[222:225], v[190:193], v[178:181], v[222:225]
    v_lshl_add_u32 v21, s77, 5, v238
    ds_read_b128 v[166:169], v249 offset:12288
    v_mfma_f32_16x16x32_bf16 v[210:213], v[174:177], v[194:197], v[210:213]
    v_and_b32 v239, 32, v0
    ds_read_b128 v[170:173], v249 offset:14336
    v_mfma_f32_16x16x32_bf16 v[226:229], v[194:197], v[178:181], v[226:229]
    v_lshl_add_u32 v22, s3, 6, v239
    s_waitcnt lgkmcnt(14)
    v_mfma_f32_16x16x32_bf16 v[230:233], v[32:35], v[242:245], v[230:233]
    v_lshrrev_b32 v239, 1, v22
    v_lshl_add_u32 v2, v21, 10, v239
    s_waitcnt lgkmcnt(13)
    v_mfma_f32_16x16x32_bf16 v[198:201], v[32:35], v[40:43], v[198:201]
    v_add_u32 v2, s62, v2
    v_mov_b64 v[28:29], -1
    s_waitcnt lgkmcnt(11)
    v_mfma_f32_16x16x32_bf16 v[234:237], v[242:245], v[36:39], v[234:237]
    v_mov_b64 v[30:31], -1
    v_lshl_add_u32 v18, s3, 12, v1
    v_mfma_f32_16x16x32_bf16 v[214:217], v[40:43], v[36:39], v[214:217]
    v_and_b32 v238, 0x300, v1
    v_add_u32 v19, v238, v1
    s_waitcnt lgkmcnt(10)
    v_mfma_f32_16x16x32_bf16 v[202:205], v[32:35], v[44:47], v[202:205]
    v_lshl_add_u32 v15, s3, 11, v1
    v_add_u32 v15, 131072, v15
    v_mfma_f32_16x16x32_bf16 v[218:221], v[44:47], v[36:39], v[218:221]
    v_xor_b32 v14, 8192, v15
    v_lshl_add_u32 v17, s3, 8, v3
    s_waitcnt lgkmcnt(9)
    v_mfma_f32_16x16x32_bf16 v[206:209], v[32:35], v[48:51], v[206:209]
    v_add_u32 v17, 161792, v17
    v_xor_b32 v16, 1024, v17
    v_mfma_f32_16x16x32_bf16 v[222:225], v[48:51], v[36:39], v[222:225]
    s_lshr_b32 s51, s4, 3
    s_lshl_b32 s1, s5, 2
    s_waitcnt lgkmcnt(8)
    v_mfma_f32_16x16x32_bf16 v[210:213], v[32:35], v[52:55], v[210:213]
    s_add_u32 s1, s1, s51
    s_and_b32 s0, s4, 7
    v_mfma_f32_16x16x32_bf16 v[226:229], v[52:55], v[36:39], v[226:229]
    s_lshl_b32 s47, s4, 7
    s_add_u32 s47, s47, s74
    s_waitcnt lgkmcnt(0)
    s_barrier
    ds_read_b64_tr_b16 v[174:175], v251 offset:0
    ds_read_b64_tr_b16 v[176:177], v251 offset:512
    ds_read_b128 v[182:185], v248 offset:16384
    ds_read_b64_tr_b16 v[178:179], v251 offset:8192
    ds_read_b64_tr_b16 v[180:181], v251 offset:8704
    v_mfma_f32_16x16x32_bf16 v[230:233], v[150:153], v[242:245], v[230:233]
    s_lshl_b32 s48, s4, 2
    ds_read_b128 v[186:189], v248 offset:18432
    v_mfma_f32_16x16x32_bf16 v[198:201], v[150:153], v[158:161], v[198:201]
    s_add_u32 s48, s48, s76
    ds_read_b128 v[190:193], v248 offset:20480
    v_mfma_f32_16x16x32_bf16 v[234:237], v[242:245], v[154:157], v[234:237]
    ds_read_b128 v[194:197], v248 offset:22528
    v_mfma_f32_16x16x32_bf16 v[214:217], v[158:161], v[154:157], v[214:217]
    ds_read_b64_tr_b16 v[32:33], v251 offset:4096
    ds_read_b64_tr_b16 v[34:35], v251 offset:4608
    v_mfma_f32_16x16x32_bf16 v[202:205], v[150:153], v[162:165], v[202:205]
    ds_read_b128 v[40:43], v249 offset:16384
    v_mfma_f32_16x16x32_bf16 v[218:221], v[162:165], v[154:157], v[218:221]
    ds_read_b64_tr_b16 v[36:37], v251 offset:12288
    ds_read_b64_tr_b16 v[38:39], v251 offset:12800
    v_mfma_f32_16x16x32_bf16 v[206:209], v[150:153], v[166:169], v[206:209]
    ds_read_b128 v[44:47], v249 offset:18432
    v_mfma_f32_16x16x32_bf16 v[222:225], v[166:169], v[154:157], v[222:225]
    ds_read_b128 v[48:51], v249 offset:20480
    v_mfma_f32_16x16x32_bf16 v[210:213], v[150:153], v[170:173], v[210:213]
    ds_read_b128 v[52:55], v249 offset:22528
    v_mfma_f32_16x16x32_bf16 v[226:229], v[170:173], v[154:157], v[226:229]
    s_waitcnt lgkmcnt(14)
    v_mfma_f32_16x16x32_bf16 v[230:233], v[174:177], v[242:245], v[230:233]
    s_waitcnt lgkmcnt(13)
    v_mfma_f32_16x16x32_bf16 v[198:201], v[174:177], v[182:185], v[198:201]
    s_waitcnt lgkmcnt(11)
    v_mfma_f32_16x16x32_bf16 v[234:237], v[242:245], v[178:181], v[234:237]
    v_mfma_f32_16x16x32_bf16 v[214:217], v[182:185], v[178:181], v[214:217]
    s_waitcnt lgkmcnt(10)
    v_mfma_f32_16x16x32_bf16 v[202:205], v[174:177], v[186:189], v[202:205]
    v_mfma_f32_16x16x32_bf16 v[218:221], v[186:189], v[178:181], v[218:221]
    s_waitcnt lgkmcnt(9)
    v_mfma_f32_16x16x32_bf16 v[206:209], v[174:177], v[190:193], v[206:209]
    v_mfma_f32_16x16x32_bf16 v[222:225], v[190:193], v[178:181], v[222:225]
    s_waitcnt lgkmcnt(8)
    v_mfma_f32_16x16x32_bf16 v[210:213], v[174:177], v[194:197], v[210:213]
    v_mfma_f32_16x16x32_bf16 v[226:229], v[194:197], v[178:181], v[226:229]
    s_waitcnt lgkmcnt(0)
    s_barrier
    ds_read_b64_tr_b16 v[150:151], v251 offset:16384
    ds_read_b64_tr_b16 v[152:153], v251 offset:16896
    ds_read_b128 v[158:161], v248 offset:24576
    ds_read_b64_tr_b16 v[154:155], v251 offset:24576
    ds_read_b64_tr_b16 v[156:157], v251 offset:25088
    v_mfma_f32_16x16x32_bf16 v[230:233], v[32:35], v[242:245], v[230:233]
    ds_read_b128 v[162:165], v248 offset:26624
    v_mfma_f32_16x16x32_bf16 v[198:201], v[32:35], v[40:43], v[198:201]
    ds_read_b128 v[166:169], v248 offset:28672
    v_mfma_f32_16x16x32_bf16 v[234:237], v[242:245], v[36:39], v[234:237]
    ds_read_b128 v[170:173], v248 offset:30720
    v_mfma_f32_16x16x32_bf16 v[214:217], v[40:43], v[36:39], v[214:217]
    ds_read_b64_tr_b16 v[174:175], v251 offset:20480
    ds_read_b64_tr_b16 v[176:177], v251 offset:20992
    v_mfma_f32_16x16x32_bf16 v[202:205], v[32:35], v[44:47], v[202:205]
    ds_read_b128 v[182:185], v249 offset:24576
    v_mfma_f32_16x16x32_bf16 v[218:221], v[44:47], v[36:39], v[218:221]
    ds_read_b64_tr_b16 v[178:179], v251 offset:28672
    ds_read_b64_tr_b16 v[180:181], v251 offset:29184
    v_mfma_f32_16x16x32_bf16 v[206:209], v[32:35], v[48:51], v[206:209]
    ds_read_b128 v[186:189], v249 offset:26624
    v_mfma_f32_16x16x32_bf16 v[222:225], v[48:51], v[36:39], v[222:225]
    ds_read_b128 v[190:193], v249 offset:28672
    v_mfma_f32_16x16x32_bf16 v[210:213], v[32:35], v[52:55], v[210:213]
    ds_read_b128 v[194:197], v249 offset:30720
    v_mfma_f32_16x16x32_bf16 v[226:229], v[52:55], v[36:39], v[226:229]
    s_waitcnt lgkmcnt(14)
    v_mfma_f32_16x16x32_bf16 v[230:233], v[150:153], v[242:245], v[230:233]
    s_waitcnt lgkmcnt(13)
    v_mfma_f32_16x16x32_bf16 v[198:201], v[150:153], v[158:161], v[198:201]
    s_waitcnt lgkmcnt(11)
    v_mfma_f32_16x16x32_bf16 v[234:237], v[242:245], v[154:157], v[234:237]
    v_mfma_f32_16x16x32_bf16 v[214:217], v[158:161], v[154:157], v[214:217]
    s_waitcnt lgkmcnt(10)
    v_mfma_f32_16x16x32_bf16 v[202:205], v[150:153], v[162:165], v[202:205]
    v_mfma_f32_16x16x32_bf16 v[218:221], v[162:165], v[154:157], v[218:221]
    s_waitcnt lgkmcnt(9)
    v_mfma_f32_16x16x32_bf16 v[206:209], v[150:153], v[166:169], v[206:209]
    v_mfma_f32_16x16x32_bf16 v[222:225], v[166:169], v[154:157], v[222:225]
    s_waitcnt lgkmcnt(8)
    v_mfma_f32_16x16x32_bf16 v[210:213], v[150:153], v[170:173], v[210:213]
    v_mfma_f32_16x16x32_bf16 v[226:229], v[170:173], v[154:157], v[226:229]
    s_waitcnt lgkmcnt(0)
    s_barrier
    ds_read_b64_tr_b16 v[32:33], v251 offset:32768
    ds_read_b64_tr_b16 v[34:35], v251 offset:33280
    ds_read_b128 v[40:43], v248 offset:32768
    ds_read_b64_tr_b16 v[36:37], v251 offset:40960
    ds_read_b64_tr_b16 v[38:39], v251 offset:41472
    v_mfma_f32_16x16x32_bf16 v[230:233], v[174:177], v[242:245], v[230:233]
    ds_read_b128 v[44:47], v248 offset:34816
    v_mfma_f32_16x16x32_bf16 v[198:201], v[174:177], v[182:185], v[198:201]
    ds_read_b128 v[48:51], v248 offset:36864
    v_mfma_f32_16x16x32_bf16 v[234:237], v[242:245], v[178:181], v[234:237]
    ds_read_b128 v[52:55], v248 offset:38912
    v_mfma_f32_16x16x32_bf16 v[214:217], v[182:185], v[178:181], v[214:217]
    ds_read_b64_tr_b16 v[150:151], v251 offset:36864
    ds_read_b64_tr_b16 v[152:153], v251 offset:37376
    v_mfma_f32_16x16x32_bf16 v[202:205], v[174:177], v[186:189], v[202:205]
    ds_read_b128 v[158:161], v249 offset:32768
    v_mfma_f32_16x16x32_bf16 v[218:221], v[186:189], v[178:181], v[218:221]
    ds_read_b64_tr_b16 v[154:155], v251 offset:45056
    ds_read_b64_tr_b16 v[156:157], v251 offset:45568
    v_mfma_f32_16x16x32_bf16 v[206:209], v[174:177], v[190:193], v[206:209]
    ds_read_b128 v[162:165], v249 offset:34816
    v_mfma_f32_16x16x32_bf16 v[222:225], v[190:193], v[178:181], v[222:225]
    ds_read_b128 v[166:169], v249 offset:36864
    v_mfma_f32_16x16x32_bf16 v[210:213], v[174:177], v[194:197], v[210:213]
    ds_read_b128 v[170:173], v249 offset:38912
    v_mfma_f32_16x16x32_bf16 v[226:229], v[194:197], v[178:181], v[226:229]
    s_waitcnt lgkmcnt(14)
    v_mfma_f32_16x16x32_bf16 v[230:233], v[32:35], v[242:245], v[230:233]
    s_waitcnt lgkmcnt(13)
    v_mfma_f32_16x16x32_bf16 v[198:201], v[32:35], v[40:43], v[198:201]
    s_waitcnt lgkmcnt(11)
    v_mfma_f32_16x16x32_bf16 v[234:237], v[242:245], v[36:39], v[234:237]
    v_mfma_f32_16x16x32_bf16 v[214:217], v[40:43], v[36:39], v[214:217]
    s_waitcnt lgkmcnt(10)
    v_mfma_f32_16x16x32_bf16 v[202:205], v[32:35], v[44:47], v[202:205]
    v_mfma_f32_16x16x32_bf16 v[218:221], v[44:47], v[36:39], v[218:221]
    s_waitcnt lgkmcnt(9)
    v_mfma_f32_16x16x32_bf16 v[206:209], v[32:35], v[48:51], v[206:209]
    v_mfma_f32_16x16x32_bf16 v[222:225], v[48:51], v[36:39], v[222:225]
    s_waitcnt lgkmcnt(8)
    v_mfma_f32_16x16x32_bf16 v[210:213], v[32:35], v[52:55], v[210:213]
    v_mfma_f32_16x16x32_bf16 v[226:229], v[52:55], v[36:39], v[226:229]
    s_waitcnt lgkmcnt(0)
    s_barrier
    ds_read_b64_tr_b16 v[174:175], v250 offset:0
    ds_read_b64_tr_b16 v[176:177], v250 offset:512
    ds_read_b128 v[182:185], v248 offset:40960
    ds_read_b64_tr_b16 v[178:179], v250 offset:8192
    ds_read_b64_tr_b16 v[180:181], v250 offset:8704
    v_mfma_f32_16x16x32_bf16 v[230:233], v[150:153], v[242:245], v[230:233]
    ds_read_b128 v[186:189], v248 offset:43008
    v_mfma_f32_16x16x32_bf16 v[198:201], v[150:153], v[158:161], v[198:201]
    ds_read_b128 v[190:193], v248 offset:45056
    v_mfma_f32_16x16x32_bf16 v[234:237], v[242:245], v[154:157], v[234:237]
    ds_read_b128 v[194:197], v248 offset:47104
    v_mfma_f32_16x16x32_bf16 v[214:217], v[158:161], v[154:157], v[214:217]
    ds_read_b64_tr_b16 v[32:33], v250 offset:4096
    ds_read_b64_tr_b16 v[34:35], v250 offset:4608
    v_mfma_f32_16x16x32_bf16 v[202:205], v[150:153], v[162:165], v[202:205]
    ds_read_b128 v[40:43], v249 offset:40960
    v_mfma_f32_16x16x32_bf16 v[218:221], v[162:165], v[154:157], v[218:221]
    ds_read_b64_tr_b16 v[36:37], v250 offset:12288
    ds_read_b64_tr_b16 v[38:39], v250 offset:12800
    v_mfma_f32_16x16x32_bf16 v[206:209], v[150:153], v[166:169], v[206:209]
    ds_read_b128 v[44:47], v249 offset:43008
    v_mfma_f32_16x16x32_bf16 v[222:225], v[166:169], v[154:157], v[222:225]
    ds_read_b128 v[48:51], v249 offset:45056
    v_mfma_f32_16x16x32_bf16 v[210:213], v[150:153], v[170:173], v[210:213]
    ds_read_b128 v[52:55], v249 offset:47104
    v_mfma_f32_16x16x32_bf16 v[226:229], v[170:173], v[154:157], v[226:229]
    s_waitcnt lgkmcnt(14)
    v_mfma_f32_16x16x32_bf16 v[230:233], v[174:177], v[242:245], v[230:233]
    s_waitcnt lgkmcnt(13)
    v_mfma_f32_16x16x32_bf16 v[198:201], v[174:177], v[182:185], v[198:201]
    s_waitcnt lgkmcnt(11)
    v_mfma_f32_16x16x32_bf16 v[234:237], v[242:245], v[178:181], v[234:237]
    v_mfma_f32_16x16x32_bf16 v[214:217], v[182:185], v[178:181], v[214:217]
    s_waitcnt lgkmcnt(10)
    v_mfma_f32_16x16x32_bf16 v[202:205], v[174:177], v[186:189], v[202:205]
    v_mfma_f32_16x16x32_bf16 v[218:221], v[186:189], v[178:181], v[218:221]
    s_waitcnt lgkmcnt(9)
    v_mfma_f32_16x16x32_bf16 v[206:209], v[174:177], v[190:193], v[206:209]
    v_mfma_f32_16x16x32_bf16 v[222:225], v[190:193], v[178:181], v[222:225]
    s_waitcnt lgkmcnt(8)
    v_mfma_f32_16x16x32_bf16 v[210:213], v[174:177], v[194:197], v[210:213]
    v_mfma_f32_16x16x32_bf16 v[226:229], v[194:197], v[178:181], v[226:229]
    s_waitcnt lgkmcnt(0)
    s_barrier
    ds_read_b64_tr_b16 v[150:151], v250 offset:16384
    ds_read_b64_tr_b16 v[152:153], v250 offset:16896
    ds_read_b128 v[158:161], v248 offset:49152
    ds_read_b64_tr_b16 v[154:155], v250 offset:24576
    ds_read_b64_tr_b16 v[156:157], v250 offset:25088
    v_mfma_f32_16x16x32_bf16 v[230:233], v[32:35], v[242:245], v[230:233]
    ds_read_b128 v[162:165], v248 offset:51200
    v_mfma_f32_16x16x32_bf16 v[198:201], v[32:35], v[40:43], v[198:201]
    ds_read_b128 v[166:169], v248 offset:53248
    v_mfma_f32_16x16x32_bf16 v[234:237], v[242:245], v[36:39], v[234:237]
    ds_read_b128 v[170:173], v248 offset:55296
    v_mfma_f32_16x16x32_bf16 v[214:217], v[40:43], v[36:39], v[214:217]
    ds_read_b64_tr_b16 v[174:175], v250 offset:20480
    ds_read_b64_tr_b16 v[176:177], v250 offset:20992
    v_mfma_f32_16x16x32_bf16 v[202:205], v[32:35], v[44:47], v[202:205]
    ds_read_b128 v[182:185], v249 offset:49152
    v_mfma_f32_16x16x32_bf16 v[218:221], v[44:47], v[36:39], v[218:221]
    ds_read_b64_tr_b16 v[178:179], v250 offset:28672
    ds_read_b64_tr_b16 v[180:181], v250 offset:29184
    v_mfma_f32_16x16x32_bf16 v[206:209], v[32:35], v[48:51], v[206:209]
    ds_read_b128 v[186:189], v249 offset:51200
    v_mfma_f32_16x16x32_bf16 v[222:225], v[48:51], v[36:39], v[222:225]
    ds_read_b128 v[190:193], v249 offset:53248
    v_mfma_f32_16x16x32_bf16 v[210:213], v[32:35], v[52:55], v[210:213]
    ds_read_b128 v[194:197], v249 offset:55296
    v_mfma_f32_16x16x32_bf16 v[226:229], v[52:55], v[36:39], v[226:229]
    s_waitcnt lgkmcnt(14)
    v_mfma_f32_16x16x32_bf16 v[230:233], v[150:153], v[242:245], v[230:233]
    s_waitcnt lgkmcnt(13)
    v_mfma_f32_16x16x32_bf16 v[198:201], v[150:153], v[158:161], v[198:201]
    s_waitcnt lgkmcnt(11)
    v_mfma_f32_16x16x32_bf16 v[234:237], v[242:245], v[154:157], v[234:237]
    v_mfma_f32_16x16x32_bf16 v[214:217], v[158:161], v[154:157], v[214:217]
    s_waitcnt lgkmcnt(10)
    v_mfma_f32_16x16x32_bf16 v[202:205], v[150:153], v[162:165], v[202:205]
    v_mfma_f32_16x16x32_bf16 v[218:221], v[162:165], v[154:157], v[218:221]
    s_waitcnt lgkmcnt(9)
    v_mfma_f32_16x16x32_bf16 v[206:209], v[150:153], v[166:169], v[206:209]
    v_mfma_f32_16x16x32_bf16 v[222:225], v[166:169], v[154:157], v[222:225]
    s_waitcnt lgkmcnt(8)
    v_mfma_f32_16x16x32_bf16 v[210:213], v[150:153], v[170:173], v[210:213]
    v_mfma_f32_16x16x32_bf16 v[226:229], v[170:173], v[154:157], v[226:229]
    s_waitcnt lgkmcnt(0)
    s_barrier
    ds_read_b64_tr_b16 v[32:33], v251 offset:0
    ds_read_b64_tr_b16 v[34:35], v251 offset:512
    ds_read_b128 v[40:43], v248 offset:57344
    ds_read_b64_tr_b16 v[36:37], v251 offset:8192
    ds_read_b64_tr_b16 v[38:39], v251 offset:8704
    v_mfma_f32_16x16x32_bf16 v[230:233], v[174:177], v[242:245], v[230:233]
    ds_read_b128 v[44:47], v248 offset:59392
    v_mfma_f32_16x16x32_bf16 v[198:201], v[174:177], v[182:185], v[198:201]
    ds_read_b128 v[48:51], v248 offset:61440
    v_mfma_f32_16x16x32_bf16 v[234:237], v[242:245], v[178:181], v[234:237]
    ds_read_b128 v[52:55], v248 offset:63488
    v_mfma_f32_16x16x32_bf16 v[214:217], v[182:185], v[178:181], v[214:217]
    ds_read_b64_tr_b16 v[150:151], v251 offset:4096
    ds_read_b64_tr_b16 v[152:153], v251 offset:4608
    v_mfma_f32_16x16x32_bf16 v[202:205], v[174:177], v[186:189], v[202:205]
    ds_read_b128 v[158:161], v249 offset:57344
    v_mfma_f32_16x16x32_bf16 v[218:221], v[186:189], v[178:181], v[218:221]
    ds_read_b64_tr_b16 v[154:155], v251 offset:12288
    ds_read_b64_tr_b16 v[156:157], v251 offset:12800
    v_mfma_f32_16x16x32_bf16 v[206:209], v[174:177], v[190:193], v[206:209]
    ds_read_b128 v[162:165], v249 offset:59392
    v_mfma_f32_16x16x32_bf16 v[222:225], v[190:193], v[178:181], v[222:225]
    ds_read_b128 v[166:169], v249 offset:61440
    v_mfma_f32_16x16x32_bf16 v[210:213], v[174:177], v[194:197], v[210:213]
    ds_read_b128 v[170:173], v249 offset:63488
    v_mfma_f32_16x16x32_bf16 v[226:229], v[194:197], v[178:181], v[226:229]
    v_and_b32 v26, 15, v0
    v_lshlrev_b32 v26, 2, v26
    v_add_u32 v26, 156672, v26
    ds_read2_b32 v[64:65], v26 offset0:0 offset1:16
    ds_read2_b32 v[66:67], v26 offset0:32 offset1:48
    ds_read2_b32 v[68:69], v26 offset0:64 offset1:80
    ds_read2_b32 v[70:71], v26 offset0:96 offset1:112
    s_waitcnt lgkmcnt(15)
    v_mfma_f32_16x16x32_bf16 v[230:233], v[32:35], v[242:245], v[230:233]
    v_mfma_f32_16x16x32_bf16 v[198:201], v[32:35], v[40:43], v[198:201]
    v_mfma_f32_16x16x32_bf16 v[234:237], v[242:245], v[36:39], v[234:237]
    v_mfma_f32_16x16x32_bf16 v[214:217], v[40:43], v[36:39], v[214:217]
    s_waitcnt lgkmcnt(14)
    v_mfma_f32_16x16x32_bf16 v[202:205], v[32:35], v[44:47], v[202:205]
    v_mfma_f32_16x16x32_bf16 v[218:221], v[44:47], v[36:39], v[218:221]
    s_waitcnt lgkmcnt(13)
    v_mfma_f32_16x16x32_bf16 v[206:209], v[32:35], v[48:51], v[206:209]
    v_mfma_f32_16x16x32_bf16 v[222:225], v[48:51], v[36:39], v[222:225]
    s_waitcnt lgkmcnt(12)
    v_mfma_f32_16x16x32_bf16 v[210:213], v[32:35], v[52:55], v[210:213]
    v_mfma_f32_16x16x32_bf16 v[226:229], v[52:55], v[36:39], v[226:229]
    v_lshrrev_b32 v26, 4, v0
    v_lshlrev_b32 v26, 4, v26
    v_add_u32 v26, 156672, v26
    s_waitcnt lgkmcnt(0)
    v_mfma_f32_16x16x32_bf16 v[230:233], v[150:153], v[242:245], v[230:233]
    ds_read_b128 v[174:177], v26 offset:0
    v_mfma_f32_16x16x32_bf16 v[198:201], v[150:153], v[158:161], v[198:201]
    ds_read_b128 v[178:181], v26 offset:64
    v_mfma_f32_16x16x32_bf16 v[202:205], v[150:153], v[162:165], v[202:205]
    ds_read_b128 v[182:185], v26 offset:128
    v_mfma_f32_16x16x32_bf16 v[206:209], v[150:153], v[166:169], v[206:209]
    ds_read_b128 v[186:189], v26 offset:192
    v_mfma_f32_16x16x32_bf16 v[210:213], v[150:153], v[170:173], v[210:213]
    ds_read_b128 v[32:35], v26 offset:256
    v_mfma_f32_16x16x32_bf16 v[234:237], v[242:245], v[154:157], v[234:237]
    ds_read_b128 v[36:39], v26 offset:320
    v_mfma_f32_16x16x32_bf16 v[214:217], v[158:161], v[154:157], v[214:217]
    ds_read_b128 v[40:43], v26 offset:384
    v_mfma_f32_16x16x32_bf16 v[218:221], v[162:165], v[154:157], v[218:221]
    ds_read_b128 v[44:47], v26 offset:448
    v_mfma_f32_16x16x32_bf16 v[222:225], v[166:169], v[154:157], v[222:225]
    v_mfma_f32_16x16x32_bf16 v[226:229], v[170:173], v[154:157], v[226:229]
    s_add_u32 s49, s53, 8192
    v_pk_fma_f32 v[198:199], v[64:65], v[230:231], v[198:199] op_sel:[0,0,0] op_sel_hi:[0,1,1] neg_lo:[1,0,0] neg_hi:[1,0,0]
    v_pk_fma_f32 v[200:201], v[64:65], v[232:233], v[200:201] op_sel:[0,0,0] op_sel_hi:[0,1,1] neg_lo:[1,0,0] neg_hi:[1,0,0]
    v_pk_fma_f32 v[202:203], v[64:65], v[230:231], v[202:203] op_sel:[1,0,0] op_sel_hi:[1,1,1] neg_lo:[1,0,0] neg_hi:[1,0,0]
    v_pk_fma_f32 v[204:205], v[64:65], v[232:233], v[204:205] op_sel:[1,0,0] op_sel_hi:[1,1,1] neg_lo:[1,0,0] neg_hi:[1,0,0]
    v_pk_fma_f32 v[206:207], v[66:67], v[230:231], v[206:207] op_sel:[0,0,0] op_sel_hi:[0,1,1] neg_lo:[1,0,0] neg_hi:[1,0,0]
    v_pk_fma_f32 v[208:209], v[66:67], v[232:233], v[208:209] op_sel:[0,0,0] op_sel_hi:[0,1,1] neg_lo:[1,0,0] neg_hi:[1,0,0]
    v_pk_fma_f32 v[210:211], v[66:67], v[230:231], v[210:211] op_sel:[1,0,0] op_sel_hi:[1,1,1] neg_lo:[1,0,0] neg_hi:[1,0,0]
    v_pk_fma_f32 v[212:213], v[66:67], v[232:233], v[212:213] op_sel:[1,0,0] op_sel_hi:[1,1,1] neg_lo:[1,0,0] neg_hi:[1,0,0]
    v_pk_mul_f32 v[198:199], v[68:69], v[198:199] op_sel:[0,0] op_sel_hi:[0,1]
    v_pk_mul_f32 v[200:201], v[68:69], v[200:201] op_sel:[0,0] op_sel_hi:[0,1]
    v_pk_mul_f32 v[202:203], v[68:69], v[202:203] op_sel:[1,0] op_sel_hi:[1,1]
    v_pk_mul_f32 v[204:205], v[68:69], v[204:205] op_sel:[1,0] op_sel_hi:[1,1]
    v_pk_mul_f32 v[206:207], v[70:71], v[206:207] op_sel:[0,0] op_sel_hi:[0,1]
    v_pk_mul_f32 v[208:209], v[70:71], v[208:209] op_sel:[0,0] op_sel_hi:[0,1]
    v_pk_mul_f32 v[210:211], v[70:71], v[210:211] op_sel:[1,0] op_sel_hi:[1,1]
    v_pk_mul_f32 v[212:213], v[70:71], v[212:213] op_sel:[1,0] op_sel_hi:[1,1]
    v_cvt_pk_bf16_f32 v72, v198, v199
    v_cvt_pk_bf16_f32 v73, v200, v201
    v_cvt_pk_bf16_f32 v74, v202, v203
    v_cvt_pk_bf16_f32 v75, v204, v205
    v_cvt_pk_bf16_f32 v84, v206, v207
    v_cvt_pk_bf16_f32 v85, v208, v209
    v_cvt_pk_bf16_f32 v86, v210, v211
    v_cvt_pk_bf16_f32 v87, v212, v213
    v_permlane16_swap_b32 v72, v74
    v_permlane16_swap_b32 v73, v75
    v_permlane16_swap_b32 v84, v86
    v_permlane16_swap_b32 v85, v87
    buffer_store_dwordx4 v[72:75], v10, s[16:19], s53 offen sc1
    buffer_store_dwordx4 v[84:87], v10, s[16:19], s49 offen sc1
    s_waitcnt lgkmcnt(0)
    v_pk_fma_f32 v[214:215], v[174:175], v[234:235], v[214:215] neg_lo:[1,0,0] neg_hi:[1,0,0]
    v_pk_fma_f32 v[216:217], v[176:177], v[234:235], v[216:217] neg_lo:[1,0,0] neg_hi:[1,0,0]
    v_pk_fma_f32 v[218:219], v[178:179], v[234:235], v[218:219] neg_lo:[1,0,0] neg_hi:[1,0,0]
    v_pk_fma_f32 v[220:221], v[180:181], v[234:235], v[220:221] neg_lo:[1,0,0] neg_hi:[1,0,0]
    v_pk_fma_f32 v[222:223], v[182:183], v[234:235], v[222:223] neg_lo:[1,0,0] neg_hi:[1,0,0]
    v_pk_fma_f32 v[224:225], v[184:185], v[234:235], v[224:225] neg_lo:[1,0,0] neg_hi:[1,0,0]
    v_pk_fma_f32 v[226:227], v[186:187], v[234:235], v[226:227] neg_lo:[1,0,0] neg_hi:[1,0,0]
    v_pk_fma_f32 v[228:229], v[188:189], v[234:235], v[228:229] neg_lo:[1,0,0] neg_hi:[1,0,0]
    v_pk_mul_f32 v[214:215], v[32:33], v[214:215]
    v_pk_mul_f32 v[216:217], v[34:35], v[216:217]
    v_pk_mul_f32 v[218:219], v[36:37], v[218:219]
    v_pk_mul_f32 v[220:221], v[38:39], v[220:221]
    v_pk_mul_f32 v[222:223], v[40:41], v[222:223]
    v_pk_mul_f32 v[224:225], v[42:43], v[224:225]
    v_pk_mul_f32 v[226:227], v[44:45], v[226:227]
    v_pk_mul_f32 v[228:229], v[46:47], v[228:229]
    v_cvt_pk_bf16_f32 v190, v214, v215
    v_cvt_pk_bf16_f32 v191, v216, v217
    v_cvt_pk_bf16_f32 v192, v218, v219
    v_cvt_pk_bf16_f32 v193, v220, v221
    v_cvt_pk_bf16_f32 v194, v222, v223
    v_cvt_pk_bf16_f32 v195, v224, v225
    v_cvt_pk_bf16_f32 v196, v226, v227
    v_cvt_pk_bf16_f32 v197, v228, v229
    v_permlane16_swap_b32 v190, v192
    v_permlane16_swap_b32 v191, v193
    v_permlane16_swap_b32 v194, v196
    v_permlane16_swap_b32 v195, v197
    buffer_store_dwordx4 v[190:193], v10, s[16:19], s53 offen offset:1024 sc1
    buffer_store_dwordx4 v[194:197], v10, s[16:19], s49 offen offset:1024 sc1
    s_add_u32 s58, s16, 6291456
    s_addc_u32 s59, s17, 0
    s_load_dword s44, s[58:59], 0
    s_barrier
    v_xor_b32 v26, 4096, v25
    v_add_u32 v27, 157696, v3
    ds_write_b128 v26, v[84:87]
    ds_write_b128 v26, v[194:197] offset:8192
    ds_write_b32 v27, v7
    ds_write_b32 v27, v7 offset:2048
    ds_write_b32 v27, v7 offset:2304
    v_mov_b32 v76, v190
    v_mov_b32 v77, v191
    v_mov_b32 v78, v192
    v_mov_b32 v79, v193
    v_mov_b64 v[32:33], 0
    v_mov_b64 v[34:35], 0
    v_mov_b64 v[36:37], 0
    v_mov_b64 v[38:39], 0
    v_mov_b64 v[40:41], 0
    v_mov_b64 v[42:43], 0
    v_mov_b64 v[44:45], 0
    v_mov_b64 v[46:47], 0
    v_mov_b64 v[48:49], 0
    v_mov_b64 v[50:51], 0
    v_mov_b64 v[52:53], 0
    v_mov_b64 v[54:55], 0
    v_mov_b64 v[56:57], 0
    v_mov_b64 v[58:59], 0
    v_mov_b64 v[60:61], 0
    v_mov_b64 v[62:63], 0
    v_permlane16_swap_b32 v76, v80
    v_permlane16_swap_b32 v77, v81
    v_permlane16_swap_b32 v78, v82
    v_permlane16_swap_b32 v79, v83
    s_waitcnt lgkmcnt(0)
    s_mul_i32 s44, s44, 1664525
    s_add_u32 s44, s44, 1013904223
    v_mov_b32 v8, s44
    s_and_b32 s66, s4, 7
    s_xor_b32 s66, s66, s5
    s_xor_b32 s50, s3, 1
    s_or_b32 s66, s66, s50
    s_cbranch_scc0 L_cand
    s_barrier
L_cand_ret:
    s_waitcnt vmcnt(0)
    s_mov_b64 exec, 1
    buffer_store_dword v8, v7, s[16:19], s48 offen
    s_mov_b64 exec, -1
    s_mov_b32 s54, 2
L_hint:
    buffer_load_dword v27, v149, s[16:19], s76 offen sc1
    s_waitcnt vmcnt(0)
    v_cmp_ne_u32 vcc, s44, v27
    s_and_b32 s50, s4, 28
    s_lshr_b64 vcc, vcc, s50
    s_mov_b32 s78, vcc_lo
    s_and_b32 s49, s78, 0xf
    s_cbranch_scc0 L_hint_ok
    s_sub_u32 s54, s54, 1
    s_cmp_lg_u32 s54, 0
    s_cbranch_scc1 L_hint
L_hint_ok:
    s_lshl_b32 s49, s6, 2
    s_add_u32 s49, s49, 157760
    s_mov_b64 exec, 1
    buffer_store_dword v8, v7, s[16:19], s47 offen sc1
    v_mov_b32 v26, s49
    v_mov_b32 v27, s78
    ds_write_b32 v26, v27
    s_mov_b64 exec, -1
    s_waitcnt lgkmcnt(0)
    s_and_b32 s49, s78, 0xf
    s_cbranch_scc1 L_noearly
    buffer_load_dwordx4 v[84:87], v11, s[16:19], s53 offen sc1
    s_mov_b64 exec, s[56:57]
    buffer_load_dwordx4 v[88:91], v11, s[16:19], s53 offen offset:1024 sc1
    buffer_load_dwordx4 v[92:95], v11, s[16:19], s53 offen offset:1280 sc1
    s_mov_b64 exec, -1
    buffer_load_dwordx4 v[96:99], v12, s[16:19], s53 offen sc1
    s_mov_b64 exec, s[56:57]
    buffer_load_dwordx4 v[100:103], v12, s[16:19], s53 offen offset:1024 sc1
    buffer_load_dwordx4 v[104:107], v12, s[16:19], s53 offen offset:1280 sc1
    s_mov_b64 exec, -1
    buffer_load_dwordx4 v[108:111], v13, s[16:19], s53 offen sc1
    s_mov_b64 exec, s[56:57]
    buffer_load_dwordx4 v[112:115], v13, s[16:19], s53 offen offset:1024 sc1
    buffer_load_dwordx4 v[116:119], v13, s[16:19], s53 offen offset:1280 sc1
    s_mov_b64 exec, -1
L_noearly:
    s_cmp_eq_u32 s66, 0
    s_cbranch_scc1 L_cand2
L_cand2_ret:
    s_setprio 3
    s_barrier
    ds_read_b128 v[64:67], v25
    ds_read_b128 v[68:71], v25 offset:8192
L_att:
    s_and_b32 s49, s78, 0xf
    s_cbranch_scc1 L_hint2
L_hint2_ret:
    s_waitcnt lgkmcnt(0)
    v_mfma_f32_32x32x16_bf16 v[150:165], v[72:75], v[64:67], 0
    v_mfma_f32_32x32x16_bf16 v[166:181], v[72:75], v[68:71], 0
L_att2:
    s_nop 10
    v_exp_f32 v150, v150
    v_exp_f32 v151, v151
    v_exp_f32 v152, v152
    v_exp_f32 v153, v153
    v_exp_f32 v154, v154
    v_exp_f32 v155, v155
    v_exp_f32 v156, v156
    v_exp_f32 v157, v157
    v_exp_f32 v158, v158
    v_exp_f32 v159, v159
    v_smfmac_f32_32x32x32_bf16 v[32:47], v[76:79], v[150:157], v6
    v_exp_f32 v160, v160
    v_exp_f32 v161, v161
    v_exp_f32 v162, v162
    v_exp_f32 v163, v163
    v_exp_f32 v164, v164
    v_exp_f32 v165, v165
    v_exp_f32 v166, v166
    v_exp_f32 v167, v167
    v_smfmac_f32_32x32x32_bf16 v[32:47], v[80:83], v[158:165], v6
    s_and_b32 s49, s78, 0xf
    s_cbranch_scc1 L_slowstart
L_slowstart_ret:
    v_exp_f32 v168, v168
    v_exp_f32 v169, v169
    v_exp_f32 v170, v170
    v_exp_f32 v171, v171
    v_exp_f32 v172, v172
    v_exp_f32 v173, v173
    v_exp_f32 v174, v174
    v_exp_f32 v175, v175
    v_smfmac_f32_32x32x32_bf16 v[48:63], v[76:79], v[166:173], v6
    v_exp_f32 v176, v176
    v_exp_f32 v177, v177
    v_exp_f32 v178, v178
    v_exp_f32 v179, v179
    v_exp_f32 v180, v180
    v_exp_f32 v181, v181
    s_waitcnt vmcnt(6)
    v_mfma_f32_32x32x16_bf16 v[150:165], v[84:87], v[64:67], 0
    s_nop 11
    v_exp_f32 v150, v150
    v_exp_f32 v151, v151
    v_smfmac_f32_32x32x32_bf16 v[48:63], v[80:83], v[174:181], v6
    buffer_load_dword v26, v149, s[16:19], s76 offen sc1
    v_exp_f32 v152, v152
    v_exp_f32 v153, v153
    v_exp_f32 v154, v154
    v_mfma_f32_32x32x16_bf16 v[166:181], v[84:87], v[68:71], 0
    v_exp_f32 v155, v155
    v_exp_f32 v156, v156
    v_exp_f32 v157, v157
    v_exp_f32 v158, v158
    v_exp_f32 v159, v159
    v_smfmac_f32_32x32x32_bf16 v[32:47], v[88:91], v[150:157], v6
    v_exp_f32 v160, v160
    v_exp_f32 v161, v161
    v_exp_f32 v162, v162
    v_exp_f32 v163, v163
    v_exp_f32 v164, v164
    v_exp_f32 v165, v165
    v_exp_f32 v166, v166
    v_exp_f32 v167, v167
    v_smfmac_f32_32x32x32_bf16 v[32:47], v[92:95], v[158:165], v6
    v_exp_f32 v168, v168
    v_exp_f32 v169, v169
    v_exp_f32 v170, v170
    s_waitcnt vmcnt(4)
    v_mfma_f32_32x32x16_bf16 v[150:165], v[96:99], v[64:67], 0
    v_exp_f32 v171, v171
    v_exp_f32 v172, v172
    v_exp_f32 v173, v173
    v_exp_f32 v174, v174
    v_exp_f32 v175, v175
    v_smfmac_f32_32x32x32_bf16 v[48:63], v[88:91], v[166:173], v6
    v_exp_f32 v176, v176
    v_exp_f32 v177, v177
    v_exp_f32 v178, v178
    v_exp_f32 v179, v179
    v_exp_f32 v180, v180
    v_exp_f32 v181, v181
    s_waitcnt vmcnt(0)
    v_cmp_ne_u32 vcc, s44, v26
    s_and_b32 s50, s4, 28
    s_lshr_b64 vcc, vcc, s50
    s_mov_b32 s78, vcc_lo
    v_exp_f32 v150, v150
    v_exp_f32 v151, v151
    v_smfmac_f32_32x32x32_bf16 v[48:63], v[92:95], v[174:181], v6
    s_and_b32 s49, s78, 0xf0
    s_cbranch_scc1 L_grp1
L_grp1_ret:
    s_add_u32 s53, s53, 0x10000
    s_and_b32 s53, s53, 0x7ffff
    buffer_load_dwordx4 v[120:123], v10, s[16:19], s53 offen sc1
    s_mov_b64 exec, s[56:57]
    buffer_load_dwordx4 v[124:127], v10, s[16:19], s53 offen offset:1024 sc1
    buffer_load_dwordx4 v[128:131], v10, s[16:19], s53 offen offset:1280 sc1
    s_mov_b64 exec, -1
    v_exp_f32 v152, v152
    v_exp_f32 v153, v153
    v_exp_f32 v154, v154
    v_mfma_f32_32x32x16_bf16 v[166:181], v[96:99], v[68:71], 0
    v_exp_f32 v155, v155
    v_exp_f32 v156, v156
    v_exp_f32 v157, v157
    v_exp_f32 v158, v158
    v_exp_f32 v159, v159
    v_smfmac_f32_32x32x32_bf16 v[32:47], v[100:103], v[150:157], v6
    v_exp_f32 v160, v160
    v_exp_f32 v161, v161
    v_exp_f32 v162, v162
    v_exp_f32 v163, v163
    v_exp_f32 v164, v164
    v_exp_f32 v165, v165
    v_exp_f32 v166, v166
    v_exp_f32 v167, v167
    v_smfmac_f32_32x32x32_bf16 v[32:47], v[104:107], v[158:165], v6
    v_exp_f32 v168, v168
    v_exp_f32 v169, v169
    v_exp_f32 v170, v170
    v_mfma_f32_32x32x16_bf16 v[150:165], v[108:111], v[64:67], 0
    buffer_load_dwordx4 v[132:135], v11, s[16:19], s53 offen sc1
    s_mov_b64 exec, s[56:57]
    buffer_load_dwordx4 v[136:139], v11, s[16:19], s53 offen offset:1024 sc1
    buffer_load_dwordx4 v[140:143], v11, s[16:19], s53 offen offset:1280 sc1
    s_mov_b64 exec, -1
    v_exp_f32 v171, v171
    v_exp_f32 v172, v172
    v_exp_f32 v173, v173
    v_exp_f32 v174, v174
    v_exp_f32 v175, v175
    v_smfmac_f32_32x32x32_bf16 v[48:63], v[100:103], v[166:173], v6
    v_exp_f32 v176, v176
    v_exp_f32 v177, v177
    v_exp_f32 v178, v178
    v_exp_f32 v179, v179
    v_exp_f32 v180, v180
    v_exp_f32 v181, v181
    s_cmp_eq_u32 s3, 0
    s_cbranch_scc1 L_st0
L_st0_skip:
    s_and_b32 s49, s3, 5
    s_cmp_eq_u32 s49, 1
    s_cbranch_scc1 L_st1
L_st1_skip:
    v_exp_f32 v150, v150
    v_exp_f32 v151, v151
    v_smfmac_f32_32x32x32_bf16 v[48:63], v[104:107], v[174:181], v6
    v_exp_f32 v152, v152
    v_exp_f32 v153, v153
    v_exp_f32 v154, v154
    v_mfma_f32_32x32x16_bf16 v[166:181], v[108:111], v[68:71], 0
    v_exp_f32 v155, v155
    v_exp_f32 v156, v156
    v_exp_f32 v157, v157
    v_exp_f32 v158, v158
    v_exp_f32 v159, v159
    v_smfmac_f32_32x32x32_bf16 v[32:47], v[112:115], v[150:157], v6
    v_exp_f32 v160, v160
    v_exp_f32 v161, v161
    v_exp_f32 v162, v162
    buffer_load_dwordx4 v[72:75], v12, s[16:19], s53 offen sc1
    s_mov_b64 exec, s[56:57]
    buffer_load_dwordx4 v[76:79], v12, s[16:19], s53 offen offset:1024 sc1
    buffer_load_dwordx4 v[80:83], v12, s[16:19], s53 offen offset:1280 sc1
    s_mov_b64 exec, -1
    v_exp_f32 v163, v163
    v_exp_f32 v164, v164
    v_exp_f32 v165, v165
    v_exp_f32 v166, v166
    v_exp_f32 v167, v167
    v_smfmac_f32_32x32x32_bf16 v[32:47], v[116:119], v[158:165], v6
    v_exp_f32 v168, v168
    v_exp_f32 v169, v169
    v_exp_f32 v170, v170
    s_waitcnt vmcnt(6)
    v_mfma_f32_32x32x16_bf16 v[150:165], v[120:123], v[64:67], 0
    v_exp_f32 v171, v171
    v_exp_f32 v172, v172
    v_exp_f32 v173, v173
    v_exp_f32 v174, v174
    v_exp_f32 v175, v175
    v_smfmac_f32_32x32x32_bf16 v[48:63], v[112:115], v[166:173], v6
    v_exp_f32 v176, v176
    v_exp_f32 v177, v177
    v_exp_f32 v178, v178
    v_exp_f32 v179, v179
    v_exp_f32 v180, v180
    v_exp_f32 v181, v181
    v_exp_f32 v150, v150
    v_exp_f32 v151, v151
    v_smfmac_f32_32x32x32_bf16 v[48:63], v[116:119], v[174:181], v6
    v_exp_f32 v152, v152
    v_exp_f32 v153, v153
    v_exp_f32 v154, v154
    v_mfma_f32_32x32x16_bf16 v[166:181], v[120:123], v[68:71], 0
    v_exp_f32 v155, v155
    v_exp_f32 v156, v156
    v_exp_f32 v157, v157
    v_exp_f32 v158, v158
    v_exp_f32 v159, v159
    v_smfmac_f32_32x32x32_bf16 v[32:47], v[124:127], v[150:157], v6
    v_exp_f32 v160, v160
    v_exp_f32 v161, v161
    v_exp_f32 v162, v162
    buffer_load_dwordx4 v[84:87], v13, s[16:19], s53 offen sc1
    s_mov_b64 exec, s[56:57]
    buffer_load_dwordx4 v[88:91], v13, s[16:19], s53 offen offset:1024 sc1
    buffer_load_dwordx4 v[92:95], v13, s[16:19], s53 offen offset:1280 sc1
    s_mov_b64 exec, -1
    v_exp_f32 v163, v163
    v_exp_f32 v164, v164
    v_exp_f32 v165, v165
    v_exp_f32 v166, v166
    v_exp_f32 v167, v167
    v_smfmac_f32_32x32x32_bf16 v[32:47], v[128:131], v[158:165], v6
    v_exp_f32 v168, v168
    v_exp_f32 v169, v169
    v_exp_f32 v170, v170
    s_waitcnt vmcnt(6)
    v_mfma_f32_32x32x16_bf16 v[150:165], v[132:135], v[64:67], 0
    v_exp_f32 v171, v171
    v_exp_f32 v172, v172
    v_exp_f32 v173, v173
    v_exp_f32 v174, v174
    v_exp_f32 v175, v175
    v_smfmac_f32_32x32x32_bf16 v[48:63], v[124:127], v[166:173], v6
    v_exp_f32 v176, v176
    v_exp_f32 v177, v177
    v_exp_f32 v178, v178
    v_exp_f32 v179, v179
    v_exp_f32 v180, v180
    v_exp_f32 v181, v181
    v_exp_f32 v150, v150
    v_exp_f32 v151, v151
    v_smfmac_f32_32x32x32_bf16 v[48:63], v[128:131], v[174:181], v6
    v_exp_f32 v152, v152
    v_exp_f32 v153, v153
    v_exp_f32 v154, v154
    v_mfma_f32_32x32x16_bf16 v[166:181], v[132:135], v[68:71], 0
    v_exp_f32 v155, v155
    v_exp_f32 v156, v156
    v_exp_f32 v157, v157
    v_exp_f32 v158, v158
    v_exp_f32 v159, v159
    v_smfmac_f32_32x32x32_bf16 v[32:47], v[136:139], v[150:157], v6
    v_exp_f32 v160, v160
    v_exp_f32 v161, v161
    v_exp_f32 v162, v162
    s_and_b32 s49, s78, 0xf00
    s_cbranch_scc1 L_grp2
L_grp2_ret:
    s_add_u32 s53, s53, 0x10000
    s_and_b32 s53, s53, 0x7ffff
    buffer_load_dwordx4 v[96:99], v10, s[16:19], s53 offen sc1
    s_mov_b64 exec, s[56:57]
    buffer_load_dwordx4 v[100:103], v10, s[16:19], s53 offen offset:1024 sc1
    buffer_load_dwordx4 v[104:107], v10, s[16:19], s53 offen offset:1280 sc1
    s_mov_b64 exec, -1
    v_exp_f32 v163, v163
    v_exp_f32 v164, v164
    v_exp_f32 v165, v165
    v_exp_f32 v166, v166
    v_exp_f32 v167, v167
    v_smfmac_f32_32x32x32_bf16 v[32:47], v[140:143], v[158:165], v6
    v_exp_f32 v168, v168
    v_exp_f32 v169, v169
    v_exp_f32 v170, v170
    s_waitcnt vmcnt(6)
    v_mfma_f32_32x32x16_bf16 v[150:165], v[72:75], v[64:67], 0
    v_exp_f32 v171, v171
    v_exp_f32 v172, v172
    v_exp_f32 v173, v173
    v_exp_f32 v174, v174
    v_exp_f32 v175, v175
    v_smfmac_f32_32x32x32_bf16 v[48:63], v[136:139], v[166:173], v6
    v_exp_f32 v176, v176
    v_exp_f32 v177, v177
    v_exp_f32 v178, v178
    v_exp_f32 v179, v179
    v_exp_f32 v180, v180
    v_exp_f32 v181, v181
L_st0_ret:
    v_exp_f32 v150, v150
    v_exp_f32 v151, v151
    v_smfmac_f32_32x32x32_bf16 v[48:63], v[140:143], v[174:181], v6
    v_exp_f32 v152, v152
    v_exp_f32 v153, v153
    v_exp_f32 v154, v154
    v_mfma_f32_32x32x16_bf16 v[166:181], v[72:75], v[68:71], 0
    v_exp_f32 v155, v155
    v_exp_f32 v156, v156
    v_exp_f32 v157, v157
    v_exp_f32 v158, v158
    v_exp_f32 v159, v159
    v_smfmac_f32_32x32x32_bf16 v[32:47], v[76:79], v[150:157], v6
    v_exp_f32 v160, v160
    v_exp_f32 v161, v161
    v_exp_f32 v162, v162
    buffer_load_dwordx4 v[108:111], v11, s[16:19], s53 offen sc1
    s_mov_b64 exec, s[56:57]
    buffer_load_dwordx4 v[112:115], v11, s[16:19], s53 offen offset:1024 sc1
    buffer_load_dwordx4 v[116:119], v11, s[16:19], s53 offen offset:1280 sc1
    s_mov_b64 exec, -1
    v_exp_f32 v163, v163
    v_exp_f32 v164, v164
    v_exp_f32 v165, v165
    v_exp_f32 v166, v166
    v_exp_f32 v167, v167
    v_smfmac_f32_32x32x32_bf16 v[32:47], v[80:83], v[158:165], v6
    v_exp_f32 v168, v168
    v_exp_f32 v169, v169
    v_exp_f32 v170, v170
    s_waitcnt vmcnt(6)
    v_mfma_f32_32x32x16_bf16 v[150:165], v[84:87], v[64:67], 0
    v_exp_f32 v171, v171
    v_exp_f32 v172, v172
    v_exp_f32 v173, v173
    v_exp_f32 v174, v174
    v_exp_f32 v175, v175
    v_smfmac_f32_32x32x32_bf16 v[48:63], v[76:79], v[166:173], v6
    v_exp_f32 v176, v176
    v_exp_f32 v177, v177
    v_exp_f32 v178, v178
    v_exp_f32 v179, v179
    v_exp_f32 v180, v180
    v_exp_f32 v181, v181
    v_exp_f32 v150, v150
    v_exp_f32 v151, v151
    v_smfmac_f32_32x32x32_bf16 v[48:63], v[80:83], v[174:181], v6
    v_exp_f32 v152, v152
    v_exp_f32 v153, v153
    v_exp_f32 v154, v154
    v_mfma_f32_32x32x16_bf16 v[166:181], v[84:87], v[68:71], 0
    v_exp_f32 v155, v155
    v_exp_f32 v156, v156
    v_exp_f32 v157, v157
    v_exp_f32 v158, v158
    v_exp_f32 v159, v159
    v_smfmac_f32_32x32x32_bf16 v[32:47], v[88:91], v[150:157], v6
    v_exp_f32 v160, v160
    v_exp_f32 v161, v161
    v_exp_f32 v162, v162
    buffer_load_dwordx4 v[120:123], v12, s[16:19], s53 offen sc1
    s_mov_b64 exec, s[56:57]
    buffer_load_dwordx4 v[124:127], v12, s[16:19], s53 offen offset:1024 sc1
    buffer_load_dwordx4 v[128:131], v12, s[16:19], s53 offen offset:1280 sc1
    s_mov_b64 exec, -1
    v_exp_f32 v163, v163
    v_exp_f32 v164, v164
    v_exp_f32 v165, v165
    v_exp_f32 v166, v166
    v_exp_f32 v167, v167
    v_smfmac_f32_32x32x32_bf16 v[32:47], v[92:95], v[158:165], v6
    v_exp_f32 v168, v168
    v_exp_f32 v169, v169
    v_exp_f32 v170, v170
    s_waitcnt vmcnt(6)
    v_mfma_f32_32x32x16_bf16 v[150:165], v[96:99], v[64:67], 0
    v_exp_f32 v171, v171
    v_exp_f32 v172, v172
    v_exp_f32 v173, v173
    v_exp_f32 v174, v174
    v_exp_f32 v175, v175
    v_smfmac_f32_32x32x32_bf16 v[48:63], v[88:91], v[166:173], v6
    v_exp_f32 v176, v176
    v_exp_f32 v177, v177
    v_exp_f32 v178, v178
    v_exp_f32 v179, v179
    v_exp_f32 v180, v180
    v_exp_f32 v181, v181
    v_exp_f32 v150, v150
    v_exp_f32 v151, v151
    v_smfmac_f32_32x32x32_bf16 v[48:63], v[92:95], v[174:181], v6
    v_exp_f32 v152, v152
    v_exp_f32 v153, v153
    v_exp_f32 v154, v154
    v_mfma_f32_32x32x16_bf16 v[166:181], v[96:99], v[68:71], 0
    v_exp_f32 v155, v155
    v_exp_f32 v156, v156
    v_exp_f32 v157, v157
    v_exp_f32 v158, v158
    v_exp_f32 v159, v159
    v_smfmac_f32_32x32x32_bf16 v[32:47], v[100:103], v[150:157], v6
    v_exp_f32 v160, v160
    v_exp_f32 v161, v161
    v_exp_f32 v162, v162
    buffer_load_dwordx4 v[132:135], v13, s[16:19], s53 offen sc1
    s_mov_b64 exec, s[56:57]
    buffer_load_dwordx4 v[136:139], v13, s[16:19], s53 offen offset:1024 sc1
    buffer_load_dwordx4 v[140:143], v13, s[16:19], s53 offen offset:1280 sc1
    s_mov_b64 exec, -1
    v_exp_f32 v163, v163
    v_exp_f32 v164, v164
    v_exp_f32 v165, v165
    v_exp_f32 v166, v166
    v_exp_f32 v167, v167
    v_smfmac_f32_32x32x32_bf16 v[32:47], v[104:107], v[158:165], v6
    v_exp_f32 v168, v168
    v_exp_f32 v169, v169
    v_exp_f32 v170, v170
    s_waitcnt vmcnt(6)
    v_mfma_f32_32x32x16_bf16 v[150:165], v[108:111], v[64:67], 0
    v_exp_f32 v171, v171
    v_exp_f32 v172, v172
    v_exp_f32 v173, v173
    v_exp_f32 v174, v174
    v_exp_f32 v175, v175
    v_smfmac_f32_32x32x32_bf16 v[48:63], v[100:103], v[166:173], v6
    v_exp_f32 v176, v176
    v_exp_f32 v177, v177
    v_exp_f32 v178, v178
    v_exp_f32 v179, v179
    v_exp_f32 v180, v180
    v_exp_f32 v181, v181
    v_exp_f32 v150, v150
    v_exp_f32 v151, v151
    v_smfmac_f32_32x32x32_bf16 v[48:63], v[104:107], v[174:181], v6
    v_exp_f32 v152, v152
    v_exp_f32 v153, v153
    v_exp_f32 v154, v154
    v_mfma_f32_32x32x16_bf16 v[166:181], v[108:111], v[68:71], 0
    v_exp_f32 v155, v155
    v_exp_f32 v156, v156
    v_exp_f32 v157, v157
    v_exp_f32 v158, v158
    v_exp_f32 v159, v159
    v_smfmac_f32_32x32x32_bf16 v[32:47], v[112:115], v[150:157], v6
    v_exp_f32 v160, v160
    v_exp_f32 v161, v161
    v_exp_f32 v162, v162
    s_and_b32 s49, s78, 0xf000
    s_cbranch_scc1 L_grp3
L_grp3_ret:
    s_add_u32 s53, s53, 0x10000
    s_and_b32 s53, s53, 0x7ffff
    buffer_load_dwordx4 v[72:75], v10, s[16:19], s53 offen sc1
    s_mov_b64 exec, s[56:57]
    buffer_load_dwordx4 v[76:79], v10, s[16:19], s53 offen offset:1024 sc1
    buffer_load_dwordx4 v[80:83], v10, s[16:19], s53 offen offset:1280 sc1
    s_mov_b64 exec, -1
    v_exp_f32 v163, v163
    v_exp_f32 v164, v164
    v_exp_f32 v165, v165
    v_exp_f32 v166, v166
    v_exp_f32 v167, v167
    v_smfmac_f32_32x32x32_bf16 v[32:47], v[116:119], v[158:165], v6
    v_exp_f32 v168, v168
    v_exp_f32 v169, v169
    v_exp_f32 v170, v170
    s_waitcnt vmcnt(6)
    v_mfma_f32_32x32x16_bf16 v[150:165], v[120:123], v[64:67], 0
    v_exp_f32 v171, v171
    v_exp_f32 v172, v172
    v_exp_f32 v173, v173
    v_exp_f32 v174, v174
    v_exp_f32 v175, v175
    v_smfmac_f32_32x32x32_bf16 v[48:63], v[112:115], v[166:173], v6
    v_exp_f32 v176, v176
    v_exp_f32 v177, v177
    v_exp_f32 v178, v178
    s_add_u32 m0, s45, 0
    s_mov_b32 s49, 0
    buffer_load_dwordx4 v5, s[20:23], s49 offen lds
    v_exp_f32 v179, v179
    v_exp_f32 v180, v180
    v_exp_f32 v181, v181
    v_exp_f32 v150, v150
    v_exp_f32 v151, v151
    v_smfmac_f32_32x32x32_bf16 v[48:63], v[116:119], v[174:181], v6
    v_exp_f32 v152, v152
    v_exp_f32 v153, v153
    v_exp_f32 v154, v154
    v_mfma_f32_32x32x16_bf16 v[166:181], v[120:123], v[68:71], 0
    v_exp_f32 v155, v155
    v_exp_f32 v156, v156
    v_exp_f32 v157, v157
    v_exp_f32 v158, v158
    v_exp_f32 v159, v159
    v_smfmac_f32_32x32x32_bf16 v[32:47], v[124:127], v[150:157], v6
    v_exp_f32 v160, v160
    v_exp_f32 v161, v161
    v_exp_f32 v162, v162
    buffer_load_dwordx4 v[84:87], v11, s[16:19], s53 offen sc1
    s_mov_b64 exec, s[56:57]
    buffer_load_dwordx4 v[88:91], v11, s[16:19], s53 offen offset:1024 sc1
    buffer_load_dwordx4 v[92:95], v11, s[16:19], s53 offen offset:1280 sc1
    s_mov_b64 exec, -1
    v_exp_f32 v163, v163
    v_exp_f32 v164, v164
    v_exp_f32 v165, v165
    v_exp_f32 v166, v166
    v_exp_f32 v167, v167
    v_smfmac_f32_32x32x32_bf16 v[32:47], v[128:131], v[158:165], v6
    v_exp_f32 v168, v168
    v_exp_f32 v169, v169
    v_exp_f32 v170, v170
    s_waitcnt vmcnt(7)
    v_mfma_f32_32x32x16_bf16 v[150:165], v[132:135], v[64:67], 0
    v_exp_f32 v171, v171
    v_exp_f32 v172, v172
    v_exp_f32 v173, v173
    v_exp_f32 v174, v174
    v_exp_f32 v175, v175
    v_smfmac_f32_32x32x32_bf16 v[48:63], v[124:127], v[166:173], v6
    v_exp_f32 v176, v176
    v_exp_f32 v177, v177
    v_exp_f32 v178, v178
    s_add_u32 m0, s45, 8192
    s_mov_b32 s49, 65536
    buffer_load_dwordx4 v5, s[20:23], s49 offen lds
    v_exp_f32 v179, v179
    v_exp_f32 v180, v180
    v_exp_f32 v181, v181
    v_exp_f32 v150, v150
    v_exp_f32 v151, v151
    v_smfmac_f32_32x32x32_bf16 v[48:63], v[128:131], v[174:181], v6
    v_exp_f32 v152, v152
    v_exp_f32 v153, v153
    v_exp_f32 v154, v154
    v_mfma_f32_32x32x16_bf16 v[166:181], v[132:135], v[68:71], 0
    v_exp_f32 v155, v155
    v_exp_f32 v156, v156
    v_exp_f32 v157, v157
    v_exp_f32 v158, v158
    v_exp_f32 v159, v159
    v_smfmac_f32_32x32x32_bf16 v[32:47], v[136:139], v[150:157], v6
    v_exp_f32 v160, v160
    v_exp_f32 v161, v161
    v_exp_f32 v162, v162
    buffer_load_dwordx4 v[96:99], v12, s[16:19], s53 offen sc1
    s_mov_b64 exec, s[56:57]
    buffer_load_dwordx4 v[100:103], v12, s[16:19], s53 offen offset:1024 sc1
    buffer_load_dwordx4 v[104:107], v12, s[16:19], s53 offen offset:1280 sc1
    s_mov_b64 exec, -1
    v_exp_f32 v163, v163
    v_exp_f32 v164, v164
    v_exp_f32 v165, v165
    v_exp_f32 v166, v166
    v_exp_f32 v167, v167
    v_smfmac_f32_32x32x32_bf16 v[32:47], v[140:143], v[158:165], v6
    v_exp_f32 v168, v168
    v_exp_f32 v169, v169
    v_exp_f32 v170, v170
    s_waitcnt vmcnt(8)
    v_mfma_f32_32x32x16_bf16 v[150:165], v[72:75], v[64:67], 0
    v_exp_f32 v171, v171
    v_exp_f32 v172, v172
    v_exp_f32 v173, v173
    v_exp_f32 v174, v174
    v_exp_f32 v175, v175
    v_smfmac_f32_32x32x32_bf16 v[48:63], v[136:139], v[166:173], v6
    v_exp_f32 v176, v176
    v_exp_f32 v177, v177
    v_exp_f32 v178, v178
    s_add_u32 m0, s45, 16384
    s_mov_b32 s49, 131072
    buffer_load_dwordx4 v5, s[20:23], s49 offen lds
    v_exp_f32 v179, v179
    v_exp_f32 v180, v180
    v_exp_f32 v181, v181
    s_cmp_eq_u32 s3, 2
    s_cbranch_scc1 L_st2
L_st2_skip:
    v_exp_f32 v150, v150
    v_exp_f32 v151, v151
    v_smfmac_f32_32x32x32_bf16 v[48:63], v[140:143], v[174:181], v6
    v_exp_f32 v152, v152
    v_exp_f32 v153, v153
    v_exp_f32 v154, v154
    v_mfma_f32_32x32x16_bf16 v[166:181], v[72:75], v[68:71], 0
    v_exp_f32 v155, v155
    v_exp_f32 v156, v156
    v_exp_f32 v157, v157
    v_exp_f32 v158, v158
    v_exp_f32 v159, v159
    v_smfmac_f32_32x32x32_bf16 v[32:47], v[76:79], v[150:157], v6
    v_exp_f32 v160, v160
    v_exp_f32 v161, v161
    v_exp_f32 v162, v162
    buffer_load_dwordx4 v[108:111], v13, s[16:19], s53 offen sc1
    s_mov_b64 exec, s[56:57]
    buffer_load_dwordx4 v[112:115], v13, s[16:19], s53 offen offset:1024 sc1
    buffer_load_dwordx4 v[116:119], v13, s[16:19], s53 offen offset:1280 sc1
    s_mov_b64 exec, -1
    v_exp_f32 v163, v163
    v_exp_f32 v164, v164
    v_exp_f32 v165, v165
    v_exp_f32 v166, v166
    v_exp_f32 v167, v167
    v_smfmac_f32_32x32x32_bf16 v[32:47], v[80:83], v[158:165], v6
    v_exp_f32 v168, v168
    v_exp_f32 v169, v169
    v_exp_f32 v170, v170
    s_waitcnt vmcnt(8)
    v_mfma_f32_32x32x16_bf16 v[150:165], v[84:87], v[64:67], 0
    v_exp_f32 v171, v171
    v_exp_f32 v172, v172
    v_exp_f32 v173, v173
    v_exp_f32 v174, v174
    v_exp_f32 v175, v175
    v_smfmac_f32_32x32x32_bf16 v[48:63], v[76:79], v[166:173], v6
    v_exp_f32 v176, v176
    v_exp_f32 v177, v177
    v_exp_f32 v178, v178
    s_add_u32 m0, s45, 24576
    s_mov_b32 s49, 196608
    buffer_load_dwordx4 v5, s[20:23], s49 offen lds
    buffer_store_dwordx4 v[28:31], v1, s[16:19], s70 offen sc1
    s_cmp_lg_u32 s3, s5
    s_cbranch_scc1 L_noehc
    s_lshl_b32 s49, s5, 5
    s_add_u32 s49, s49, s4
    s_lshl_b32 s49, s49, 9
    s_add_u32 s49, s49, 7208960
    s_mov_b64 exec, 1
    buffer_store_dword v28, v7, s[16:19], s49 offen sc1
    s_mov_b64 exec, -1
L_noehc:
    v_exp_f32 v179, v179
    v_exp_f32 v180, v180
    v_exp_f32 v181, v181
    v_exp_f32 v150, v150
    v_exp_f32 v151, v151
    v_smfmac_f32_32x32x32_bf16 v[48:63], v[80:83], v[174:181], v6
    v_exp_f32 v152, v152
    v_exp_f32 v153, v153
    v_exp_f32 v154, v154
    v_mfma_f32_32x32x16_bf16 v[166:181], v[84:87], v[68:71], 0
    v_exp_f32 v155, v155
    v_exp_f32 v156, v156
    v_exp_f32 v157, v157
    v_exp_f32 v158, v158
    v_exp_f32 v159, v159
    v_smfmac_f32_32x32x32_bf16 v[32:47], v[88:91], v[150:157], v6
    v_exp_f32 v160, v160
    v_exp_f32 v161, v161
    v_exp_f32 v162, v162
    s_and_b32 s49, s78, 0xf0000
    s_cbranch_scc1 L_grp4
L_grp4_ret:
    s_add_u32 s53, s53, 0x10000
    s_and_b32 s53, s53, 0x7ffff
    buffer_load_dwordx4 v[120:123], v10, s[16:19], s53 offen sc1
    s_mov_b64 exec, s[56:57]
    buffer_load_dwordx4 v[124:127], v10, s[16:19], s53 offen offset:1024 sc1
    buffer_load_dwordx4 v[128:131], v10, s[16:19], s53 offen offset:1280 sc1
    s_mov_b64 exec, -1
    v_exp_f32 v163, v163
    v_exp_f32 v164, v164
    v_exp_f32 v165, v165
    v_exp_f32 v166, v166
    v_exp_f32 v167, v167
    v_smfmac_f32_32x32x32_bf16 v[32:47], v[92:95], v[158:165], v6
    v_exp_f32 v168, v168
    v_exp_f32 v169, v169
    v_exp_f32 v170, v170
    s_waitcnt vmcnt(9)
    v_mfma_f32_32x32x16_bf16 v[150:165], v[96:99], v[64:67], 0
    v_exp_f32 v171, v171
    v_exp_f32 v172, v172
    v_exp_f32 v173, v173
    v_exp_f32 v174, v174
    v_exp_f32 v175, v175
    v_smfmac_f32_32x32x32_bf16 v[48:63], v[88:91], v[166:173], v6
    v_exp_f32 v176, v176
    v_exp_f32 v177, v177
    v_exp_f32 v178, v178
    s_add_u32 m0, s45, 32768
    s_mov_b32 s49, 262144
    buffer_load_dwordx4 v5, s[20:23], s49 offen lds
    v_exp_f32 v179, v179
    v_exp_f32 v180, v180
    v_exp_f32 v181, v181
L_st1_ret:
    v_exp_f32 v150, v150
    v_exp_f32 v151, v151
    v_smfmac_f32_32x32x32_bf16 v[48:63], v[92:95], v[174:181], v6
    v_exp_f32 v152, v152
    v_exp_f32 v153, v153
    v_exp_f32 v154, v154
    v_mfma_f32_32x32x16_bf16 v[166:181], v[96:99], v[68:71], 0
    v_exp_f32 v155, v155
    v_exp_f32 v156, v156
    v_exp_f32 v157, v157
    v_exp_f32 v158, v158
    v_exp_f32 v159, v159
    v_smfmac_f32_32x32x32_bf16 v[32:47], v[100:103], v[150:157], v6
    v_exp_f32 v160, v160
    v_exp_f32 v161, v161
    v_exp_f32 v162, v162
    buffer_load_dwordx4 v[132:135], v11, s[16:19], s53 offen sc1
    s_mov_b64 exec, s[56:57]
    buffer_load_dwordx4 v[136:139], v11, s[16:19], s53 offen offset:1024 sc1
    buffer_load_dwordx4 v[140:143], v11, s[16:19], s53 offen offset:1280 sc1
    s_mov_b64 exec, -1
    v_exp_f32 v163, v163
    v_exp_f32 v164, v164
    v_exp_f32 v165, v165
    v_exp_f32 v166, v166
    v_exp_f32 v167, v167
    v_smfmac_f32_32x32x32_bf16 v[32:47], v[104:107], v[158:165], v6
    v_exp_f32 v168, v168
    v_exp_f32 v169, v169
    v_exp_f32 v170, v170
    s_waitcnt vmcnt(9)
    v_mfma_f32_32x32x16_bf16 v[150:165], v[108:111], v[64:67], 0
    v_exp_f32 v171, v171
    v_exp_f32 v172, v172
    v_exp_f32 v173, v173
    v_exp_f32 v174, v174
    v_exp_f32 v175, v175
    v_smfmac_f32_32x32x32_bf16 v[48:63], v[100:103], v[166:173], v6
    v_exp_f32 v176, v176
    v_exp_f32 v177, v177
    v_exp_f32 v178, v178
    s_add_u32 m0, s45, 40960
    s_mov_b32 s49, 327680
    buffer_load_dwordx4 v5, s[20:23], s49 offen lds
    v_exp_f32 v179, v179
    v_exp_f32 v180, v180
    v_exp_f32 v181, v181
    v_exp_f32 v150, v150
    v_exp_f32 v151, v151
    v_smfmac_f32_32x32x32_bf16 v[48:63], v[104:107], v[174:181], v6
    v_exp_f32 v152, v152
    v_exp_f32 v153, v153
    v_exp_f32 v154, v154
    v_mfma_f32_32x32x16_bf16 v[166:181], v[108:111], v[68:71], 0
    v_exp_f32 v155, v155
    v_exp_f32 v156, v156
    v_exp_f32 v157, v157
    v_exp_f32 v158, v158
    v_exp_f32 v159, v159
    v_smfmac_f32_32x32x32_bf16 v[32:47], v[112:115], v[150:157], v6
    v_exp_f32 v160, v160
    v_exp_f32 v161, v161
    v_exp_f32 v162, v162
    buffer_load_dwordx4 v[72:75], v12, s[16:19], s53 offen sc1
    s_mov_b64 exec, s[56:57]
    buffer_load_dwordx4 v[76:79], v12, s[16:19], s53 offen offset:1024 sc1
    buffer_load_dwordx4 v[80:83], v12, s[16:19], s53 offen offset:1280 sc1
    s_mov_b64 exec, -1
    v_exp_f32 v163, v163
    v_exp_f32 v164, v164
    v_exp_f32 v165, v165
    v_exp_f32 v166, v166
    v_exp_f32 v167, v167
    v_smfmac_f32_32x32x32_bf16 v[32:47], v[116:119], v[158:165], v6
    v_exp_f32 v168, v168
    v_exp_f32 v169, v169
    v_exp_f32 v170, v170
    s_waitcnt vmcnt(8)
    v_mfma_f32_32x32x16_bf16 v[150:165], v[120:123], v[64:67], 0
    v_exp_f32 v171, v171
    v_exp_f32 v172, v172
    v_exp_f32 v173, v173
    v_exp_f32 v174, v174
    v_exp_f32 v175, v175
    v_smfmac_f32_32x32x32_bf16 v[48:63], v[112:115], v[166:173], v6
    v_exp_f32 v176, v176
    v_exp_f32 v177, v177
    v_exp_f32 v178, v178
    s_add_u32 m0, s45, 49152
    s_mov_b32 s49, 393216
    buffer_load_dwordx4 v5, s[20:23], s49 offen lds
    s_mov_b64 exec, 1
    buffer_store_dword v8, v7, s[16:19], s71 offen sc1
    s_mov_b64 exec, -1
    v_exp_f32 v179, v179
    v_exp_f32 v180, v180
    v_exp_f32 v181, v181
    v_exp_f32 v150, v150
    v_exp_f32 v151, v151
    v_smfmac_f32_32x32x32_bf16 v[48:63], v[116:119], v[174:181], v6
    v_exp_f32 v152, v152
    v_exp_f32 v153, v153
    v_exp_f32 v154, v154
    v_mfma_f32_32x32x16_bf16 v[166:181], v[120:123], v[68:71], 0
    v_exp_f32 v155, v155
    v_exp_f32 v156, v156
    v_exp_f32 v157, v157
    v_exp_f32 v158, v158
    v_exp_f32 v159, v159
    v_smfmac_f32_32x32x32_bf16 v[32:47], v[124:127], v[150:157], v6
    v_exp_f32 v160, v160
    v_exp_f32 v161, v161
    v_exp_f32 v162, v162
    buffer_load_dwordx4 v[84:87], v13, s[16:19], s53 offen sc1
    s_mov_b64 exec, s[56:57]
    buffer_load_dwordx4 v[88:91], v13, s[16:19], s53 offen offset:1024 sc1
    buffer_load_dwordx4 v[92:95], v13, s[16:19], s53 offen offset:1280 sc1
    s_mov_b64 exec, -1
    v_exp_f32 v163, v163
    v_exp_f32 v164, v164
    v_exp_f32 v165, v165
    v_exp_f32 v166, v166
    v_exp_f32 v167, v167
    v_smfmac_f32_32x32x32_bf16 v[32:47], v[128:131], v[158:165], v6
    v_exp_f32 v168, v168
    v_exp_f32 v169, v169
    v_exp_f32 v170, v170
    s_waitcnt vmcnt(9)
    v_mfma_f32_32x32x16_bf16 v[150:165], v[132:135], v[64:67], 0
    v_exp_f32 v171, v171
    v_exp_f32 v172, v172
    v_exp_f32 v173, v173
    v_exp_f32 v174, v174
    v_exp_f32 v175, v175
    v_smfmac_f32_32x32x32_bf16 v[48:63], v[124:127], v[166:173], v6
    v_exp_f32 v176, v176
    v_exp_f32 v177, v177
    v_exp_f32 v178, v178
    s_add_u32 m0, s45, 57344
    s_mov_b32 s49, 458752
    buffer_load_dwordx4 v5, s[20:23], s49 offen lds
    v_exp_f32 v179, v179
    v_exp_f32 v180, v180
    v_exp_f32 v181, v181
    s_cmp_eq_u32 s3, 0
    s_cbranch_scc1 L_st3
L_st3_skip:
    v_exp_f32 v150, v150
    v_exp_f32 v151, v151
    v_smfmac_f32_32x32x32_bf16 v[48:63], v[128:131], v[174:181], v6
    v_exp_f32 v152, v152
    v_exp_f32 v153, v153
    v_exp_f32 v154, v154
    v_mfma_f32_32x32x16_bf16 v[166:181], v[132:135], v[68:71], 0
    v_exp_f32 v155, v155
    v_exp_f32 v156, v156
    v_exp_f32 v157, v157
    v_exp_f32 v158, v158
    v_exp_f32 v159, v159
    v_smfmac_f32_32x32x32_bf16 v[32:47], v[136:139], v[150:157], v6
    v_exp_f32 v160, v160
    v_exp_f32 v161, v161
    v_exp_f32 v162, v162
    s_and_b32 s49, s78, 0xf00000
    s_cbranch_scc1 L_grp5
L_grp5_ret:
    s_add_u32 s53, s53, 0x10000
    s_and_b32 s53, s53, 0x7ffff
    buffer_load_dwordx4 v[96:99], v10, s[16:19], s53 offen sc1
    s_mov_b64 exec, s[56:57]
    buffer_load_dwordx4 v[100:103], v10, s[16:19], s53 offen offset:1024 sc1
    buffer_load_dwordx4 v[104:107], v10, s[16:19], s53 offen offset:1280 sc1
    s_mov_b64 exec, -1
    v_exp_f32 v163, v163
    v_exp_f32 v164, v164
    v_exp_f32 v165, v165
    v_exp_f32 v166, v166
    v_exp_f32 v167, v167
    v_smfmac_f32_32x32x32_bf16 v[32:47], v[140:143], v[158:165], v6
    v_exp_f32 v168, v168
    v_exp_f32 v169, v169
    v_exp_f32 v170, v170
    s_waitcnt vmcnt(9)
    v_mfma_f32_32x32x16_bf16 v[150:165], v[72:75], v[64:67], 0
    v_exp_f32 v171, v171
    v_exp_f32 v172, v172
    v_exp_f32 v173, v173
    v_exp_f32 v174, v174
    v_exp_f32 v175, v175
    v_smfmac_f32_32x32x32_bf16 v[48:63], v[136:139], v[166:173], v6
    v_exp_f32 v176, v176
    v_exp_f32 v177, v177
    v_exp_f32 v178, v178
    s_add_u32 m0, s45, 65536
    s_mov_b32 s49, 128
    buffer_load_dwordx4 v5, s[20:23], s49 offen lds
    v_exp_f32 v179, v179
    v_exp_f32 v180, v180
    v_exp_f32 v181, v181
    v_exp_f32 v150, v150
    v_exp_f32 v151, v151
    v_smfmac_f32_32x32x32_bf16 v[48:63], v[140:143], v[174:181], v6
    v_exp_f32 v152, v152
    v_exp_f32 v153, v153
    v_exp_f32 v154, v154
    v_mfma_f32_32x32x16_bf16 v[166:181], v[72:75], v[68:71], 0
    v_exp_f32 v155, v155
    v_exp_f32 v156, v156
    v_exp_f32 v157, v157
    v_exp_f32 v158, v158
    v_exp_f32 v159, v159
    v_smfmac_f32_32x32x32_bf16 v[32:47], v[76:79], v[150:157], v6
    v_exp_f32 v160, v160
    v_exp_f32 v161, v161
    v_exp_f32 v162, v162
    buffer_load_dwordx4 v[108:111], v11, s[16:19], s53 offen sc1
    s_mov_b64 exec, s[56:57]
    buffer_load_dwordx4 v[112:115], v11, s[16:19], s53 offen offset:1024 sc1
    buffer_load_dwordx4 v[116:119], v11, s[16:19], s53 offen offset:1280 sc1
    s_mov_b64 exec, -1
    v_exp_f32 v163, v163
    v_exp_f32 v164, v164
    v_exp_f32 v165, v165
    v_exp_f32 v166, v166
    v_exp_f32 v167, v167
    v_smfmac_f32_32x32x32_bf16 v[32:47], v[80:83], v[158:165], v6
    v_exp_f32 v168, v168
    v_exp_f32 v169, v169
    v_exp_f32 v170, v170
    s_waitcnt vmcnt(8)
    v_mfma_f32_32x32x16_bf16 v[150:165], v[84:87], v[64:67], 0
    v_exp_f32 v171, v171
    v_exp_f32 v172, v172
    v_exp_f32 v173, v173
    v_exp_f32 v174, v174
    v_exp_f32 v175, v175
    v_smfmac_f32_32x32x32_bf16 v[48:63], v[76:79], v[166:173], v6
    v_exp_f32 v176, v176
    v_exp_f32 v177, v177
    v_exp_f32 v178, v178
    s_add_u32 m0, s45, 73728
    s_mov_b32 s49, 65664
    buffer_load_dwordx4 v5, s[20:23], s49 offen lds
    v_exp_f32 v179, v179
    v_exp_f32 v180, v180
    v_exp_f32 v181, v181
    v_exp_f32 v150, v150
    v_exp_f32 v151, v151
    v_smfmac_f32_32x32x32_bf16 v[48:63], v[80:83], v[174:181], v6
    v_exp_f32 v152, v152
    v_exp_f32 v153, v153
    v_exp_f32 v154, v154
    v_mfma_f32_32x32x16_bf16 v[166:181], v[84:87], v[68:71], 0
    v_exp_f32 v155, v155
    v_exp_f32 v156, v156
    v_exp_f32 v157, v157
    v_exp_f32 v158, v158
    v_exp_f32 v159, v159
    v_smfmac_f32_32x32x32_bf16 v[32:47], v[88:91], v[150:157], v6
    v_exp_f32 v160, v160
    v_exp_f32 v161, v161
    v_exp_f32 v162, v162
    buffer_load_dwordx4 v[120:123], v12, s[16:19], s53 offen sc1
    s_mov_b64 exec, s[56:57]
    buffer_load_dwordx4 v[124:127], v12, s[16:19], s53 offen offset:1024 sc1
    buffer_load_dwordx4 v[128:131], v12, s[16:19], s53 offen offset:1280 sc1
    s_mov_b64 exec, -1
    v_exp_f32 v163, v163
    v_exp_f32 v164, v164
    v_exp_f32 v165, v165
    v_exp_f32 v166, v166
    v_exp_f32 v167, v167
    v_smfmac_f32_32x32x32_bf16 v[32:47], v[92:95], v[158:165], v6
    v_exp_f32 v168, v168
    v_exp_f32 v169, v169
    v_exp_f32 v170, v170
    s_waitcnt vmcnt(8)
    v_mfma_f32_32x32x16_bf16 v[150:165], v[96:99], v[64:67], 0
    v_exp_f32 v171, v171
    v_exp_f32 v172, v172
    v_exp_f32 v173, v173
    v_exp_f32 v174, v174
    v_exp_f32 v175, v175
    v_smfmac_f32_32x32x32_bf16 v[48:63], v[88:91], v[166:173], v6
    v_exp_f32 v176, v176
    v_exp_f32 v177, v177
    v_exp_f32 v178, v178
    s_add_u32 m0, s45, 81920
    s_mov_b32 s49, 131200
    buffer_load_dwordx4 v5, s[20:23], s49 offen lds
    v_exp_f32 v179, v179
    v_exp_f32 v180, v180
    v_exp_f32 v181, v181
    v_exp_f32 v150, v150
    v_exp_f32 v151, v151
    v_smfmac_f32_32x32x32_bf16 v[48:63], v[92:95], v[174:181], v6
    v_exp_f32 v152, v152
    v_exp_f32 v153, v153
    v_exp_f32 v154, v154
    v_mfma_f32_32x32x16_bf16 v[166:181], v[96:99], v[68:71], 0
    v_exp_f32 v155, v155
    v_exp_f32 v156, v156
    v_exp_f32 v157, v157
    v_exp_f32 v158, v158
    v_exp_f32 v159, v159
    v_smfmac_f32_32x32x32_bf16 v[32:47], v[100:103], v[150:157], v6
    v_exp_f32 v160, v160
    v_exp_f32 v161, v161
    v_exp_f32 v162, v162
    buffer_load_dwordx4 v[132:135], v13, s[16:19], s53 offen sc1
    s_mov_b64 exec, s[56:57]
    buffer_load_dwordx4 v[136:139], v13, s[16:19], s53 offen offset:1024 sc1
    buffer_load_dwordx4 v[140:143], v13, s[16:19], s53 offen offset:1280 sc1
    s_mov_b64 exec, -1
    v_exp_f32 v163, v163
    v_exp_f32 v164, v164
    v_exp_f32 v165, v165
    v_exp_f32 v166, v166
    v_exp_f32 v167, v167
    v_smfmac_f32_32x32x32_bf16 v[32:47], v[104:107], v[158:165], v6
    v_exp_f32 v168, v168
    v_exp_f32 v169, v169
    v_exp_f32 v170, v170
    s_waitcnt vmcnt(8)
    v_mfma_f32_32x32x16_bf16 v[150:165], v[108:111], v[64:67], 0
    v_exp_f32 v171, v171
    v_exp_f32 v172, v172
    v_exp_f32 v173, v173
    v_exp_f32 v174, v174
    v_exp_f32 v175, v175
    v_smfmac_f32_32x32x32_bf16 v[48:63], v[100:103], v[166:173], v6
    v_exp_f32 v176, v176
    v_exp_f32 v177, v177
    v_exp_f32 v178, v178
    s_add_u32 m0, s45, 90112
    s_mov_b32 s49, 196736
    buffer_load_dwordx4 v5, s[20:23], s49 offen lds
    v_exp_f32 v179, v179
    v_exp_f32 v180, v180
    v_exp_f32 v181, v181
L_st3_ret:
    v_exp_f32 v150, v150
    v_exp_f32 v151, v151
    v_smfmac_f32_32x32x32_bf16 v[48:63], v[104:107], v[174:181], v6
    v_exp_f32 v152, v152
    v_exp_f32 v153, v153
    v_exp_f32 v154, v154
    v_mfma_f32_32x32x16_bf16 v[166:181], v[108:111], v[68:71], 0
    v_exp_f32 v155, v155
    v_exp_f32 v156, v156
    v_exp_f32 v157, v157
    v_exp_f32 v158, v158
    v_exp_f32 v159, v159
    v_smfmac_f32_32x32x32_bf16 v[32:47], v[112:115], v[150:157], v6
    v_exp_f32 v160, v160
    v_exp_f32 v161, v161
    v_exp_f32 v162, v162
    s_and_b32 s49, s78, 0xf000000
    s_cbranch_scc1 L_grp6
L_grp6_ret:
    s_add_u32 s53, s53, 0x10000
    s_and_b32 s53, s53, 0x7ffff
    buffer_load_dwordx4 v[72:75], v10, s[16:19], s53 offen sc1
    s_mov_b64 exec, s[56:57]
    buffer_load_dwordx4 v[76:79], v10, s[16:19], s53 offen offset:1024 sc1
    buffer_load_dwordx4 v[80:83], v10, s[16:19], s53 offen offset:1280 sc1
    s_mov_b64 exec, -1
    v_exp_f32 v163, v163
    v_exp_f32 v164, v164
    v_exp_f32 v165, v165
    v_exp_f32 v166, v166
    v_exp_f32 v167, v167
    v_smfmac_f32_32x32x32_bf16 v[32:47], v[116:119], v[158:165], v6
    v_exp_f32 v168, v168
    v_exp_f32 v169, v169
    v_exp_f32 v170, v170
    s_waitcnt vmcnt(8)
    v_mfma_f32_32x32x16_bf16 v[150:165], v[120:123], v[64:67], 0
    v_exp_f32 v171, v171
    v_exp_f32 v172, v172
    v_exp_f32 v173, v173
    v_exp_f32 v174, v174
    v_exp_f32 v175, v175
    v_smfmac_f32_32x32x32_bf16 v[48:63], v[112:115], v[166:173], v6
    v_exp_f32 v176, v176
    v_exp_f32 v177, v177
    v_exp_f32 v178, v178
    s_add_u32 m0, s45, 98304
    s_mov_b32 s49, 262272
    buffer_load_dwordx4 v5, s[20:23], s49 offen lds
    v_exp_f32 v179, v179
    v_exp_f32 v180, v180
    v_exp_f32 v181, v181
    v_exp_f32 v150, v150
    v_exp_f32 v151, v151
    v_smfmac_f32_32x32x32_bf16 v[48:63], v[116:119], v[174:181], v6
    v_exp_f32 v152, v152
    v_exp_f32 v153, v153
    v_exp_f32 v154, v154
    v_mfma_f32_32x32x16_bf16 v[166:181], v[120:123], v[68:71], 0
    v_exp_f32 v155, v155
    v_exp_f32 v156, v156
    v_exp_f32 v157, v157
    v_exp_f32 v158, v158
    v_exp_f32 v159, v159
    v_smfmac_f32_32x32x32_bf16 v[32:47], v[124:127], v[150:157], v6
    v_exp_f32 v160, v160
    v_exp_f32 v161, v161
    v_exp_f32 v162, v162
    buffer_load_dwordx4 v[84:87], v11, s[16:19], s53 offen sc1
    s_mov_b64 exec, s[56:57]
    buffer_load_dwordx4 v[88:91], v11, s[16:19], s53 offen offset:1024 sc1
    buffer_load_dwordx4 v[92:95], v11, s[16:19], s53 offen offset:1280 sc1
    s_mov_b64 exec, -1
    v_exp_f32 v163, v163
    v_exp_f32 v164, v164
    v_exp_f32 v165, v165
    v_exp_f32 v166, v166
    v_exp_f32 v167, v167
    v_smfmac_f32_32x32x32_bf16 v[32:47], v[128:131], v[158:165], v6
    v_exp_f32 v168, v168
    v_exp_f32 v169, v169
    v_exp_f32 v170, v170
    s_waitcnt vmcnt(8)
    v_mfma_f32_32x32x16_bf16 v[150:165], v[132:135], v[64:67], 0
    v_exp_f32 v171, v171
    v_exp_f32 v172, v172
    v_exp_f32 v173, v173
    v_exp_f32 v174, v174
    v_exp_f32 v175, v175
    v_smfmac_f32_32x32x32_bf16 v[48:63], v[124:127], v[166:173], v6
    v_exp_f32 v176, v176
    v_exp_f32 v177, v177
    v_exp_f32 v178, v178
    s_add_u32 m0, s45, 106496
    s_mov_b32 s49, 327808
    buffer_load_dwordx4 v5, s[20:23], s49 offen lds
    v_exp_f32 v179, v179
    v_exp_f32 v180, v180
    v_exp_f32 v181, v181
    v_exp_f32 v150, v150
    v_exp_f32 v151, v151
    v_smfmac_f32_32x32x32_bf16 v[48:63], v[128:131], v[174:181], v6
    v_exp_f32 v152, v152
    v_exp_f32 v153, v153
    v_exp_f32 v154, v154
    v_mfma_f32_32x32x16_bf16 v[166:181], v[132:135], v[68:71], 0
    v_exp_f32 v155, v155
    v_exp_f32 v156, v156
    v_exp_f32 v157, v157
    v_exp_f32 v158, v158
    v_exp_f32 v159, v159
    v_smfmac_f32_32x32x32_bf16 v[32:47], v[136:139], v[150:157], v6
    v_exp_f32 v160, v160
    v_exp_f32 v161, v161
    v_exp_f32 v162, v162
    buffer_load_dwordx4 v[96:99], v12, s[16:19], s53 offen sc1
    s_mov_b64 exec, s[56:57]
    buffer_load_dwordx4 v[100:103], v12, s[16:19], s53 offen offset:1024 sc1
    buffer_load_dwordx4 v[104:107], v12, s[16:19], s53 offen offset:1280 sc1
    s_mov_b64 exec, -1
    v_exp_f32 v163, v163
    v_exp_f32 v164, v164
    v_exp_f32 v165, v165
    v_exp_f32 v166, v166
    v_exp_f32 v167, v167
    v_smfmac_f32_32x32x32_bf16 v[32:47], v[140:143], v[158:165], v6
    v_exp_f32 v168, v168
    v_exp_f32 v169, v169
    v_exp_f32 v170, v170
    s_waitcnt vmcnt(8)
    v_mfma_f32_32x32x16_bf16 v[150:165], v[72:75], v[64:67], 0
    v_exp_f32 v171, v171
    v_exp_f32 v172, v172
    v_exp_f32 v173, v173
    v_exp_f32 v174, v174
    v_exp_f32 v175, v175
    v_smfmac_f32_32x32x32_bf16 v[48:63], v[136:139], v[166:173], v6
    v_exp_f32 v176, v176
    v_exp_f32 v177, v177
    v_exp_f32 v178, v178
    s_add_u32 m0, s45, 114688
    s_mov_b32 s49, 393344
    buffer_load_dwordx4 v5, s[20:23], s49 offen lds
    v_exp_f32 v179, v179
    v_exp_f32 v180, v180
    v_exp_f32 v181, v181
    v_exp_f32 v150, v150
    v_exp_f32 v151, v151
    v_smfmac_f32_32x32x32_bf16 v[48:63], v[140:143], v[174:181], v6
    v_exp_f32 v152, v152
    v_exp_f32 v153, v153
    v_exp_f32 v154, v154
    v_mfma_f32_32x32x16_bf16 v[166:181], v[72:75], v[68:71], 0
    v_exp_f32 v155, v155
    v_exp_f32 v156, v156
    v_exp_f32 v157, v157
    v_exp_f32 v158, v158
    v_exp_f32 v159, v159
    v_smfmac_f32_32x32x32_bf16 v[32:47], v[76:79], v[150:157], v6
    v_exp_f32 v160, v160
    v_exp_f32 v161, v161
    v_exp_f32 v162, v162
    buffer_load_dwordx4 v[108:111], v13, s[16:19], s53 offen sc1
    s_mov_b64 exec, s[56:57]
    buffer_load_dwordx4 v[112:115], v13, s[16:19], s53 offen offset:1024 sc1
    buffer_load_dwordx4 v[116:119], v13, s[16:19], s53 offen offset:1280 sc1
    s_mov_b64 exec, -1
    v_exp_f32 v163, v163
    v_exp_f32 v164, v164
    v_exp_f32 v165, v165
    v_exp_f32 v166, v166
    v_exp_f32 v167, v167
    v_smfmac_f32_32x32x32_bf16 v[32:47], v[80:83], v[158:165], v6
    v_exp_f32 v168, v168
    v_exp_f32 v169, v169
    v_exp_f32 v170, v170
    s_waitcnt vmcnt(8)
    v_mfma_f32_32x32x16_bf16 v[150:165], v[84:87], v[64:67], 0
    v_exp_f32 v171, v171
    v_exp_f32 v172, v172
    v_exp_f32 v173, v173
    v_exp_f32 v174, v174
    v_exp_f32 v175, v175
    v_smfmac_f32_32x32x32_bf16 v[48:63], v[76:79], v[166:173], v6
    v_exp_f32 v176, v176
    v_exp_f32 v177, v177
    v_exp_f32 v178, v178
    s_add_u32 m0, s45, 122880
    s_mov_b32 s49, 458880
    buffer_load_dwordx4 v5, s[20:23], s49 offen lds
    v_exp_f32 v179, v179
    v_exp_f32 v180, v180
    v_exp_f32 v181, v181
L_st2_ret:
    s_cmp_lg_u32 s7, 0
    s_cbranch_scc1 L_prio25_0
    s_setprio 1
L_prio25_0:
    v_exp_f32 v150, v150
    v_exp_f32 v151, v151
    v_smfmac_f32_32x32x32_bf16 v[48:63], v[80:83], v[174:181], v6
    v_exp_f32 v152, v152
    v_exp_f32 v153, v153
    v_exp_f32 v154, v154
    v_mfma_f32_32x32x16_bf16 v[166:181], v[84:87], v[68:71], 0
    v_exp_f32 v155, v155
    v_exp_f32 v156, v156
    v_exp_f32 v157, v157
    v_exp_f32 v158, v158
    v_exp_f32 v159, v159
    v_smfmac_f32_32x32x32_bf16 v[32:47], v[88:91], v[150:157], v6
    v_exp_f32 v160, v160
    v_exp_f32 v161, v161
    v_exp_f32 v162, v162
    s_and_b32 s49, s78, 0xf0000000
    s_cbranch_scc1 L_grp7
L_grp7_ret:
    s_add_u32 s53, s53, 0x10000
    s_and_b32 s53, s53, 0x7ffff
    buffer_load_dwordx4 v[120:123], v10, s[16:19], s53 offen sc1
    s_mov_b64 exec, s[56:57]
    buffer_load_dwordx4 v[124:127], v10, s[16:19], s53 offen offset:1024 sc1
    buffer_load_dwordx4 v[128:131], v10, s[16:19], s53 offen offset:1280 sc1
    s_mov_b64 exec, -1
    v_exp_f32 v163, v163
    v_exp_f32 v164, v164
    v_exp_f32 v165, v165
    v_exp_f32 v166, v166
    v_exp_f32 v167, v167
    v_smfmac_f32_32x32x32_bf16 v[32:47], v[92:95], v[158:165], v6
    v_exp_f32 v168, v168
    v_exp_f32 v169, v169
    v_exp_f32 v170, v170
    s_waitcnt vmcnt(8)
    v_mfma_f32_32x32x16_bf16 v[150:165], v[96:99], v[64:67], 0
    v_exp_f32 v171, v171
    v_exp_f32 v172, v172
    v_exp_f32 v173, v173
    v_exp_f32 v174, v174
    v_exp_f32 v175, v175
    v_smfmac_f32_32x32x32_bf16 v[48:63], v[88:91], v[166:173], v6
    v_exp_f32 v176, v176
    v_exp_f32 v177, v177
    v_exp_f32 v178, v178
    v_exp_f32 v179, v179
    v_exp_f32 v180, v180
    v_exp_f32 v181, v181
    v_exp_f32 v150, v150
    v_exp_f32 v151, v151
    v_smfmac_f32_32x32x32_bf16 v[48:63], v[92:95], v[174:181], v6
    v_exp_f32 v152, v152
    v_exp_f32 v153, v153
    v_exp_f32 v154, v154
    v_mfma_f32_32x32x16_bf16 v[166:181], v[96:99], v[68:71], 0
    v_exp_f32 v155, v155
    v_exp_f32 v156, v156
    v_exp_f32 v157, v157
    v_exp_f32 v158, v158
    v_exp_f32 v159, v159
    v_smfmac_f32_32x32x32_bf16 v[32:47], v[100:103], v[150:157], v6
    v_exp_f32 v160, v160
    v_exp_f32 v161, v161
    v_exp_f32 v162, v162
    buffer_load_dwordx4 v[132:135], v11, s[16:19], s53 offen sc1
    s_mov_b64 exec, s[56:57]
    buffer_load_dwordx4 v[136:139], v11, s[16:19], s53 offen offset:1024 sc1
    buffer_load_dwordx4 v[140:143], v11, s[16:19], s53 offen offset:1280 sc1
    s_mov_b64 exec, -1
    v_exp_f32 v163, v163
    v_exp_f32 v164, v164
    v_exp_f32 v165, v165
    v_exp_f32 v166, v166
    v_exp_f32 v167, v167
    v_smfmac_f32_32x32x32_bf16 v[32:47], v[104:107], v[158:165], v6
    v_exp_f32 v168, v168
    v_exp_f32 v169, v169
    v_exp_f32 v170, v170
    s_waitcnt vmcnt(7)
    v_mfma_f32_32x32x16_bf16 v[150:165], v[108:111], v[64:67], 0
    v_exp_f32 v171, v171
    v_exp_f32 v172, v172
    v_exp_f32 v173, v173
    v_exp_f32 v174, v174
    v_exp_f32 v175, v175
    v_smfmac_f32_32x32x32_bf16 v[48:63], v[100:103], v[166:173], v6
    v_exp_f32 v176, v176
    v_exp_f32 v177, v177
    v_exp_f32 v178, v178
    v_exp_f32 v179, v179
    v_exp_f32 v180, v180
    v_exp_f32 v181, v181
    s_waitcnt vmcnt(6)
    v_mov_b32 v26, 157696
    v_mov_b32 v27, 1
    s_mov_b64 exec, 1
    ds_add_u32 v26, v27 offset:32
    s_mov_b64 exec, -1
    v_exp_f32 v150, v150
    v_exp_f32 v151, v151
    v_smfmac_f32_32x32x32_bf16 v[48:63], v[104:107], v[174:181], v6
    v_exp_f32 v152, v152
    v_exp_f32 v153, v153
    v_exp_f32 v154, v154
    v_mfma_f32_32x32x16_bf16 v[166:181], v[108:111], v[68:71], 0
    v_exp_f32 v155, v155
    v_exp_f32 v156, v156
    v_exp_f32 v157, v157
    v_exp_f32 v158, v158
    v_exp_f32 v159, v159
    v_smfmac_f32_32x32x32_bf16 v[32:47], v[112:115], v[150:157], v6
    v_exp_f32 v160, v160
    v_exp_f32 v161, v161
    v_exp_f32 v162, v162
    buffer_load_dwordx4 v[72:75], v12, s[16:19], s53 offen sc1
    s_mov_b64 exec, s[56:57]
    buffer_load_dwordx4 v[76:79], v12, s[16:19], s53 offen offset:1024 sc1
    buffer_load_dwordx4 v[80:83], v12, s[16:19], s53 offen offset:1280 sc1
    s_mov_b64 exec, -1
    v_exp_f32 v163, v163
    v_exp_f32 v164, v164
    v_exp_f32 v165, v165
    v_exp_f32 v166, v166
    v_exp_f32 v167, v167
    v_smfmac_f32_32x32x32_bf16 v[32:47], v[116:119], v[158:165], v6
    v_exp_f32 v168, v168
    v_exp_f32 v169, v169
    v_exp_f32 v170, v170
    s_waitcnt vmcnt(6)
    v_mfma_f32_32x32x16_bf16 v[150:165], v[120:123], v[64:67], 0
    v_exp_f32 v171, v171
    v_exp_f32 v172, v172
    v_exp_f32 v173, v173
    v_exp_f32 v174, v174
    v_exp_f32 v175, v175
    v_smfmac_f32_32x32x32_bf16 v[48:63], v[112:115], v[166:173], v6
    v_exp_f32 v176, v176
    v_exp_f32 v177, v177
    v_exp_f32 v178, v178
    v_exp_f32 v179, v179
    v_exp_f32 v180, v180
    v_exp_f32 v181, v181
    v_exp_f32 v150, v150
    v_exp_f32 v151, v151
    v_smfmac_f32_32x32x32_bf16 v[48:63], v[116:119], v[174:181], v6
    v_exp_f32 v152, v152
    v_exp_f32 v153, v153
    v_exp_f32 v154, v154
    v_mfma_f32_32x32x16_bf16 v[166:181], v[120:123], v[68:71], 0
    v_exp_f32 v155, v155
    v_exp_f32 v156, v156
    v_exp_f32 v157, v157
    v_exp_f32 v158, v158
    v_exp_f32 v159, v159
    v_smfmac_f32_32x32x32_bf16 v[32:47], v[124:127], v[150:157], v6
    v_exp_f32 v160, v160
    v_exp_f32 v161, v161
    v_exp_f32 v162, v162
    buffer_load_dwordx4 v[84:87], v13, s[16:19], s53 offen sc1
    s_mov_b64 exec, s[56:57]
    buffer_load_dwordx4 v[88:91], v13, s[16:19], s53 offen offset:1024 sc1
    buffer_load_dwordx4 v[92:95], v13, s[16:19], s53 offen offset:1280 sc1
    s_mov_b64 exec, -1
    v_exp_f32 v163, v163
    v_exp_f32 v164, v164
    v_exp_f32 v165, v165
    v_exp_f32 v166, v166
    v_exp_f32 v167, v167
    v_smfmac_f32_32x32x32_bf16 v[32:47], v[128:131], v[158:165], v6
    v_exp_f32 v168, v168
    v_exp_f32 v169, v169
    v_exp_f32 v170, v170
    s_waitcnt vmcnt(6)
    v_mfma_f32_32x32x16_bf16 v[150:165], v[132:135], v[64:67], 0
    v_exp_f32 v171, v171
    v_exp_f32 v172, v172
    v_exp_f32 v173, v173
    v_exp_f32 v174, v174
    v_exp_f32 v175, v175
    v_smfmac_f32_32x32x32_bf16 v[48:63], v[124:127], v[166:173], v6
    v_exp_f32 v176, v176
    v_exp_f32 v177, v177
    v_exp_f32 v178, v178
    buffer_load_dwordx4 v[28:31], v2, s[8:11], 0 offen
    s_mov_b32 s49, 6324224
    v_lshlrev_b32 v146, 3, v21
    buffer_load_dwordx2 v[146:147], v146, s[16:19], s49 offen sc1
    buffer_load_dword v144, v20, s[16:19], s73 offen sc1
    v_exp_f32 v179, v179
    v_exp_f32 v180, v180
    v_exp_f32 v181, v181
    v_exp_f32 v150, v150
    v_exp_f32 v151, v151
    v_smfmac_f32_32x32x32_bf16 v[48:63], v[128:131], v[174:181], v6
    v_exp_f32 v152, v152
    v_exp_f32 v153, v153
    v_exp_f32 v154, v154
    v_mfma_f32_32x32x16_bf16 v[166:181], v[132:135], v[68:71], 0
    v_exp_f32 v155, v155
    v_exp_f32 v156, v156
    v_exp_f32 v157, v157
    v_exp_f32 v158, v158
    v_exp_f32 v159, v159
    v_smfmac_f32_32x32x32_bf16 v[32:47], v[136:139], v[150:157], v6
    v_exp_f32 v160, v160
    v_exp_f32 v161, v161
    v_exp_f32 v162, v162
    v_exp_f32 v163, v163
    v_exp_f32 v164, v164
    v_exp_f32 v165, v165
    v_exp_f32 v166, v166
    v_exp_f32 v167, v167
    v_smfmac_f32_32x32x32_bf16 v[32:47], v[140:143], v[158:165], v6
    ds_read_b32 v27, v26 offset:32
    ds_read_b64 v[182:183], v26
    v_exp_f32 v168, v168
    v_exp_f32 v169, v169
    v_exp_f32 v170, v170
    s_waitcnt vmcnt(6)
    v_mfma_f32_32x32x16_bf16 v[150:165], v[72:75], v[64:67], 0
    v_exp_f32 v171, v171
    v_exp_f32 v172, v172
    v_exp_f32 v173, v173
    v_exp_f32 v174, v174
    v_exp_f32 v175, v175
    v_smfmac_f32_32x32x32_bf16 v[48:63], v[136:139], v[166:173], v6
    v_exp_f32 v176, v176
    v_exp_f32 v177, v177
    v_exp_f32 v178, v178
    s_lshl_b32 s49, s5, 5
    s_add_u32 s49, s49, s4
    s_lshl_b32 s49, s49, 9
    s_add_u32 s49, s49, 7208960
    s_mov_b32 s47, s49
    s_mov_b32 s51, 0x30800000
    s_mov_b32 s52, 0x5d800000
    v_exp_f32 v179, v179
    v_exp_f32 v180, v180
    v_exp_f32 v181, v181
    s_waitcnt lgkmcnt(0)
    v_cmp_gt_u32 vcc, 11, v27
    s_nop 0
    s_cbranch_vccnz L_guardwait
L_guardwait_ret:
    v_cmp_eq_u32 s[64:65], v21, v182
    v_cmp_eq_u32 s[66:67], v21, v183
    s_nop 0
    s_or_b64 vcc, s[64:65], s[66:67]
    s_cbranch_scc1 L_y1
L_y1_ret:
    v_exp_f32 v150, v150
    v_exp_f32 v151, v151
    v_smfmac_f32_32x32x32_bf16 v[48:63], v[140:143], v[174:181], v6
    v_exp_f32 v152, v152
    v_exp_f32 v153, v153
    v_exp_f32 v154, v154
    v_mfma_f32_32x32x16_bf16 v[166:181], v[72:75], v[68:71], 0
    v_exp_f32 v155, v155
    v_exp_f32 v156, v156
    v_exp_f32 v157, v157
    v_exp_f32 v158, v158
    v_exp_f32 v159, v159
    v_smfmac_f32_32x32x32_bf16 v[32:47], v[76:79], v[150:157], v6
    v_exp_f32 v160, v160
    v_exp_f32 v161, v161
    v_exp_f32 v162, v162
    ds_read_b64_tr_b16 v[192:193], v4 offset:0
    ds_read_b64_tr_b16 v[194:195], v4 offset:1024
    ds_read_b64_tr_b16 v[196:197], v4 offset:4096
    ds_read_b64_tr_b16 v[198:199], v4 offset:5120
    ds_read_b64_tr_b16 v[200:201], v4 offset:8192
    ds_read_b64_tr_b16 v[202:203], v4 offset:9216
    ds_read_b64_tr_b16 v[204:205], v4 offset:12288
    ds_read_b64_tr_b16 v[206:207], v4 offset:13312
    v_exp_f32 v163, v163
    v_exp_f32 v164, v164
    v_exp_f32 v165, v165
    v_exp_f32 v166, v166
    v_exp_f32 v167, v167
    v_smfmac_f32_32x32x32_bf16 v[32:47], v[80:83], v[158:165], v6
    v_exp_f32 v168, v168
    v_exp_f32 v169, v169
    v_exp_f32 v170, v170
    s_waitcnt vmcnt(3)
    v_mfma_f32_32x32x16_bf16 v[150:165], v[84:87], v[64:67], 0
    v_exp_f32 v171, v171
    v_exp_f32 v172, v172
    v_exp_f32 v173, v173
    v_exp_f32 v174, v174
    v_exp_f32 v175, v175
    v_smfmac_f32_32x32x32_bf16 v[48:63], v[76:79], v[166:173], v6
    v_exp_f32 v176, v176
    v_exp_f32 v177, v177
    v_exp_f32 v178, v178
    ds_read_b64_tr_b16 v[208:209], v4 offset:16384
    ds_read_b64_tr_b16 v[210:211], v4 offset:17408
    ds_read_b64_tr_b16 v[212:213], v4 offset:20480
    ds_read_b64_tr_b16 v[214:215], v4 offset:21504
    ds_read_b64_tr_b16 v[216:217], v4 offset:24576
    ds_read_b64_tr_b16 v[218:219], v4 offset:25600
    ds_read_b64_tr_b16 v[220:221], v4 offset:28672
    ds_read_b64_tr_b16 v[222:223], v4 offset:29696
    v_exp_f32 v179, v179
    v_exp_f32 v180, v180
    v_exp_f32 v181, v181
    s_cmp_lg_u32 s7, 1
    s_cbranch_scc1 L_prio31_1
    s_setprio 0
L_prio31_1:
    s_waitcnt vmcnt(0)
    v_cmp_ne_u32 vcc, s44, v144
    v_cmp_ne_u32 s[58:59], s44, v147
    s_nop 0
    s_or_b64 vcc, vcc, s[58:59]
    s_cbranch_vccnz L_latewait
L_latewait_ret:
    v_exp_f32 v150, v150
    v_exp_f32 v151, v151
    v_smfmac_f32_32x32x32_bf16 v[48:63], v[80:83], v[174:181], v6
    v_exp_f32 v152, v152
    v_exp_f32 v153, v153
    v_exp_f32 v154, v154
    v_mfma_f32_32x32x16_bf16 v[166:181], v[84:87], v[68:71], 0
    v_exp_f32 v155, v155
    v_exp_f32 v156, v156
    v_exp_f32 v157, v157
    v_exp_f32 v158, v158
    v_exp_f32 v159, v159
    v_smfmac_f32_32x32x32_bf16 v[32:47], v[88:91], v[150:157], v6
    v_exp_f32 v160, v160
    v_exp_f32 v161, v161
    v_exp_f32 v162, v162
    ds_read_b64_tr_b16 v[224:225], v4 offset:32768
    ds_read_b64_tr_b16 v[226:227], v4 offset:33792
    ds_read_b64_tr_b16 v[228:229], v4 offset:36864
    ds_read_b64_tr_b16 v[230:231], v4 offset:37888
    ds_read_b64_tr_b16 v[232:233], v4 offset:40960
    ds_read_b64_tr_b16 v[234:235], v4 offset:41984
    ds_read_b64_tr_b16 v[236:237], v4 offset:45056
    ds_read_b64_tr_b16 v[238:239], v4 offset:46080
    v_exp_f32 v163, v163
    v_exp_f32 v164, v164
    v_exp_f32 v165, v165
    v_exp_f32 v166, v166
    v_exp_f32 v167, v167
    v_smfmac_f32_32x32x32_bf16 v[32:47], v[92:95], v[158:165], v6
    ds_read_b64_tr_b16 v[240:241], v4 offset:49152
    ds_read_b64_tr_b16 v[242:243], v4 offset:50176
    ds_read_b64_tr_b16 v[244:245], v4 offset:53248
    ds_read_b64_tr_b16 v[246:247], v4 offset:54272
    ds_read_b64_tr_b16 v[248:249], v4 offset:57344
    ds_read_b64_tr_b16 v[250:251], v4 offset:58368
    ds_read_b64_tr_b16 v[252:253], v4 offset:61440
    ds_read_b64_tr_b16 v[254:255], v4 offset:62464
    s_or_b64 vcc, s[64:65], s[66:67]
    s_cbranch_scc1 L_y2
L_y2_ret:
    v_exp_f32 v168, v168
    v_exp_f32 v169, v169
    v_exp_f32 v170, v170
    v_exp_f32 v171, v171
    v_exp_f32 v172, v172
    v_exp_f32 v173, v173
    v_exp_f32 v174, v174
    v_exp_f32 v175, v175
    v_smfmac_f32_32x32x32_bf16 v[48:63], v[88:91], v[166:173], v6
    v_exp_f32 v176, v176
    v_exp_f32 v177, v177
    v_exp_f32 v178, v178
    ds_write_b128 v14, v[32:35]
    ds_write_b128 v14, v[36:39] offset:1024
    ds_write_b32 v16, v40
    v_exp_f32 v179, v179
    v_exp_f32 v180, v180
    v_exp_f32 v181, v181
    s_nop 1
    v_smfmac_f32_32x32x32_bf16 v[48:63], v[92:95], v[174:181], v6
    s_setprio 2
    s_waitcnt lgkmcnt(0)
    s_barrier
    ds_read_b32 v158, v17
    ds_read_b128 v[150:153], v15
    ds_read_b128 v[154:157], v15 offset:1024
    buffer_load_dword v144, v7, s[16:19], s75 offen sc1
    s_cmp_lg_u32 s3, s5
    s_cbranch_scc1 L_noeh
    s_mov_b64 exec, 1
    buffer_store_dword v8, v7, s[16:19], s47 offen sc1
    s_mov_b64 exec, -1
L_noeh:
    s_nop 2
    s_waitcnt lgkmcnt(2)
    v_add_f32 v56, v56, v158
    v_cmp_nle_f32 vcc, s51, v56
    v_cmp_nge_f32 s[58:59], s52, v56
    v_rcp_f32 v56, v56
    s_or_b64 vcc, vcc, s[58:59]
    s_waitcnt lgkmcnt(0)
    v_pk_add_f32 v[48:49], v[48:49], v[150:151]
    v_pk_add_f32 v[50:51], v[50:51], v[152:153]
    v_pk_add_f32 v[52:53], v[52:53], v[154:155]
    v_pk_add_f32 v[54:55], v[54:55], v[156:157]
    s_cbranch_vccnz L_fallback
L_fallback_ret:
    v_pk_mul_f32 v[48:49], v[56:57], v[48:49] op_sel_hi:[0,1]
    v_pk_mul_f32 v[50:51], v[56:57], v[50:51] op_sel_hi:[0,1]
    v_pk_mul_f32 v[52:53], v[56:57], v[52:53] op_sel_hi:[0,1]
    v_pk_mul_f32 v[54:55], v[56:57], v[54:55] op_sel_hi:[0,1]
    v_cvt_pk_bf16_f32 v32, v48, v49
    v_cvt_pk_bf16_f32 v33, v50, v51
    v_cvt_pk_bf16_f32 v34, v52, v53
    v_cvt_pk_bf16_f32 v35, v54, v55
    v_min_u32 v32, -2, v32
    v_min_u32 v33, -2, v33
    v_min_u32 v34, -2, v34
    v_min_u32 v35, -2, v35
    buffer_store_dwordx4 v[32:35], v1, s[16:19], s70 offen sc1
    s_setprio 0
    v_and_b32 v85, 0xffff0000, v146
    v_lshlrev_b32 v84, 16, v146
    v_rcp_f32 v85, v85
    v_lshlrev_b32 v96, 16, v28
    v_and_b32 v97, 0xffff0000, v28
    v_lshlrev_b32 v98, 16, v29
    v_and_b32 v99, 0xffff0000, v29
    v_lshlrev_b32 v100, 16, v30
    v_and_b32 v101, 0xffff0000, v30
    v_lshlrev_b32 v102, 16, v31
    v_and_b32 v103, 0xffff0000, v31
    v_pk_add_f32 v[104:105], v[96:97], v[84:85] op_sel_hi:[1,0] neg_lo:[0,1] neg_hi:[0,1]
    v_pk_add_f32 v[106:107], v[98:99], v[84:85] op_sel_hi:[1,0] neg_lo:[0,1] neg_hi:[0,1]
    v_pk_add_f32 v[108:109], v[100:101], v[84:85] op_sel_hi:[1,0] neg_lo:[0,1] neg_hi:[0,1]
    v_pk_add_f32 v[110:111], v[102:103], v[84:85] op_sel_hi:[1,0] neg_lo:[0,1] neg_hi:[0,1]
    v_cvt_pk_bf16_f32 v112, v104, v105
    v_cvt_pk_bf16_f32 v113, v106, v107
    v_cvt_pk_bf16_f32 v114, v108, v109
    v_cvt_pk_bf16_f32 v115, v110, v111
    v_lshlrev_b32 v104, 16, v112
    v_and_b32 v105, 0xffff0000, v112
    v_lshlrev_b32 v106, 16, v113
    v_and_b32 v107, 0xffff0000, v113
    v_lshlrev_b32 v108, 16, v114
    v_and_b32 v109, 0xffff0000, v114
    v_lshlrev_b32 v110, 16, v115
    v_and_b32 v111, 0xffff0000, v115
    v_pk_mul_f32 v[104:105], v[104:105], v[84:85] op_sel:[0,1]
    v_pk_mul_f32 v[106:107], v[106:107], v[84:85] op_sel:[0,1]
    v_pk_mul_f32 v[108:109], v[108:109], v[84:85] op_sel:[0,1]
    v_pk_mul_f32 v[110:111], v[110:111], v[84:85] op_sel:[0,1]
    v_cvt_pk_bf16_f32 v112, v104, v105
    v_cvt_pk_bf16_f32 v113, v106, v107
    v_cvt_pk_bf16_f32 v114, v108, v109
    v_cvt_pk_bf16_f32 v115, v110, v111
    v_lshlrev_b32 v104, 16, v112
    v_and_b32 v105, 0xffff0000, v112
    v_lshlrev_b32 v106, 16, v113
    v_and_b32 v107, 0xffff0000, v113
    v_lshlrev_b32 v108, 16, v114
    v_and_b32 v109, 0xffff0000, v114
    v_lshlrev_b32 v110, 16, v115
    v_and_b32 v111, 0xffff0000, v115
    s_mov_b32 s58, 0xbfb8aa3b
    s_mov_b32 s59, s58
    s_waitcnt vmcnt(1)
    v_cmp_ne_u32 vcc, s44, v144
    s_nop 0
    s_cbranch_vccnz L_ehwait
L_ehwait_ret:
    buffer_load_dwordx4 v[150:153], v1, s[16:19], s72 offen offset:0 sc1
    buffer_load_dwordx4 v[154:157], v1, s[16:19], s72 offen offset:1024 sc1
    buffer_load_dwordx4 v[158:161], v1, s[16:19], s72 offen offset:2048 sc1
    buffer_load_dwordx4 v[162:165], v1, s[16:19], s72 offen offset:3072 sc1
    s_or_b64 vcc, s[64:65], s[66:67]
    s_cbranch_scc1 L_y3
L_y3_ret:
    v_mov_b32 v112, 159744
    v_mov_b32 v113, 158720
    v_mov_b32 v114, 159232
    v_cndmask_b32 v112, v112, v114, s[66:67]
    v_cndmask_b32 v112, v112, v113, s[64:65]
    v_add_u32 v112, v112, v22
    ds_read_b128 v[88:91], v112
    ds_read_b128 v[92:95], v112 offset:16
    s_waitcnt lgkmcnt(0)
    v_pk_add_f32 v[104:105], v[104:105], v[88:89]
    v_pk_add_f32 v[106:107], v[106:107], v[90:91]
    v_pk_add_f32 v[108:109], v[108:109], v[92:93]
    v_pk_add_f32 v[110:111], v[110:111], v[94:95]
    v_pk_mul_f32 v[88:89], s[58:59], v[104:105]
    v_pk_mul_f32 v[90:91], s[58:59], v[106:107]
    v_pk_mul_f32 v[92:93], s[58:59], v[108:109]
    v_pk_mul_f32 v[94:95], s[58:59], v[110:111]
    v_exp_f32 v88, v88
    v_exp_f32 v89, v89
    v_exp_f32 v90, v90
    v_exp_f32 v91, v91
    v_exp_f32 v92, v92
    v_exp_f32 v93, v93
    v_exp_f32 v94, v94
    v_exp_f32 v95, v95
    v_pk_add_f32 v[88:89], v[88:89], 1.0 op_sel_hi:[1,0]
    v_pk_add_f32 v[90:91], v[90:91], 1.0 op_sel_hi:[1,0]
    v_pk_add_f32 v[92:93], v[92:93], 1.0 op_sel_hi:[1,0]
    v_pk_add_f32 v[94:95], v[94:95], 1.0 op_sel_hi:[1,0]
    v_rcp_f32 v88, v88
    v_rcp_f32 v89, v89
    v_rcp_f32 v90, v90
    v_rcp_f32 v91, v91
    v_rcp_f32 v92, v92
    v_rcp_f32 v93, v93
    v_rcp_f32 v94, v94
    v_rcp_f32 v95, v95
    v_pk_mul_f32 v[104:105], v[104:105], v[88:89]
    v_pk_mul_f32 v[106:107], v[106:107], v[90:91]
    v_pk_mul_f32 v[108:109], v[108:109], v[92:93]
    v_pk_mul_f32 v[110:111], v[110:111], v[94:95]
    v_cvt_pk_bf16_f32 v112, v104, v105
    v_cvt_pk_bf16_f32 v113, v106, v107
    v_cvt_pk_bf16_f32 v114, v108, v109
    v_cvt_pk_bf16_f32 v115, v110, v111
    v_lshlrev_b32 v104, 16, v112
    v_and_b32 v105, 0xffff0000, v112
    v_lshlrev_b32 v106, 16, v113
    v_and_b32 v107, 0xffff0000, v113
    v_lshlrev_b32 v108, 16, v114
    v_and_b32 v109, 0xffff0000, v114
    v_lshlrev_b32 v110, 16, v115
    v_and_b32 v111, 0xffff0000, v115
    s_waitcnt vmcnt(3)
    ds_write_b128 v18, v[150:153] offset:0
    v_max3_u32 v166, v150, v151, v150
    v_max3_u32 v166, v152, v153, v166
    s_waitcnt vmcnt(2)
    ds_write_b128 v18, v[154:157] offset:1024
    v_max3_u32 v166, v154, v155, v166
    v_max3_u32 v166, v156, v157, v166
    s_waitcnt vmcnt(1)
    ds_write_b128 v18, v[158:161] offset:2048
    v_max3_u32 v166, v158, v159, v166
    v_max3_u32 v166, v160, v161, v166
    s_waitcnt vmcnt(0)
    ds_write_b128 v18, v[162:165] offset:3072
    v_max3_u32 v166, v162, v163, v166
    v_max3_u32 v166, v164, v165, v166
    v_cmp_eq_u32 vcc, -1, v166
    s_nop 0
    s_cbranch_vccnz L_owait
L_owait_ret:
    s_waitcnt lgkmcnt(0)
    s_barrier
    ds_read_b128 v[32:35], v19 offset:0
    ds_read_b128 v[36:39], v19 offset:256
    ds_read_b128 v[40:43], v19 offset:2048
    ds_read_b128 v[44:47], v19 offset:2304
    ds_read_b128 v[48:51], v19 offset:4096
    ds_read_b128 v[52:55], v19 offset:4352
    ds_read_b128 v[56:59], v19 offset:6144
    s_waitcnt lgkmcnt(6)
    v_mfma_f32_16x16x32_bf16 v[116:119], v[192:195], v[32:35], 0
    ds_read_b128 v[60:63], v19 offset:6400
    s_waitcnt lgkmcnt(6)
    v_mfma_f32_16x16x32_bf16 v[120:123], v[192:195], v[36:39], 0
    ds_read_b128 v[32:35], v19 offset:8192
    s_waitcnt lgkmcnt(5)
    v_mfma_f32_16x16x32_bf16 v[116:119], v[196:199], v[40:43], v[116:119]
    ds_read_b128 v[36:39], v19 offset:8448
    v_mfma_f32_16x16x32_bf16 v[120:123], v[196:199], v[44:47], v[120:123]
    ds_read_b128 v[40:43], v19 offset:10240
    s_waitcnt lgkmcnt(5)
    v_mfma_f32_16x16x32_bf16 v[116:119], v[200:203], v[48:51], v[116:119]
    ds_read_b128 v[44:47], v19 offset:10496
    v_mfma_f32_16x16x32_bf16 v[120:123], v[200:203], v[52:55], v[120:123]
    ds_read_b128 v[48:51], v19 offset:12288
    s_waitcnt lgkmcnt(5)
    v_mfma_f32_16x16x32_bf16 v[116:119], v[204:207], v[56:59], v[116:119]
    ds_read_b128 v[52:55], v19 offset:12544
    v_mfma_f32_16x16x32_bf16 v[120:123], v[204:207], v[60:63], v[120:123]
    ds_read_b128 v[56:59], v19 offset:14336
    s_waitcnt lgkmcnt(5)
    v_mfma_f32_16x16x32_bf16 v[116:119], v[208:211], v[32:35], v[116:119]
    ds_read_b128 v[60:63], v19 offset:14592
    v_mfma_f32_16x16x32_bf16 v[120:123], v[208:211], v[36:39], v[120:123]
    ds_read_b128 v[32:35], v19 offset:16384
    s_waitcnt lgkmcnt(5)
    v_mfma_f32_16x16x32_bf16 v[116:119], v[212:215], v[40:43], v[116:119]
    ds_read_b128 v[36:39], v19 offset:16640
    v_mfma_f32_16x16x32_bf16 v[120:123], v[212:215], v[44:47], v[120:123]
    ds_read_b128 v[40:43], v19 offset:18432
    s_waitcnt lgkmcnt(5)
    v_mfma_f32_16x16x32_bf16 v[116:119], v[216:219], v[48:51], v[116:119]
    ds_read_b128 v[44:47], v19 offset:18688
    v_mfma_f32_16x16x32_bf16 v[120:123], v[216:219], v[52:55], v[120:123]
    ds_read_b128 v[48:51], v19 offset:20480
    s_waitcnt lgkmcnt(5)
    v_mfma_f32_16x16x32_bf16 v[116:119], v[220:223], v[56:59], v[116:119]
    ds_read_b128 v[52:55], v19 offset:20736
    v_mfma_f32_16x16x32_bf16 v[120:123], v[220:223], v[60:63], v[120:123]
    ds_read_b128 v[56:59], v19 offset:22528
    s_waitcnt lgkmcnt(5)
    v_mfma_f32_16x16x32_bf16 v[116:119], v[224:227], v[32:35], v[116:119]
    ds_read_b128 v[60:63], v19 offset:22784
    v_mfma_f32_16x16x32_bf16 v[120:123], v[224:227], v[36:39], v[120:123]
    ds_read_b128 v[32:35], v19 offset:24576
    s_waitcnt lgkmcnt(5)
    v_mfma_f32_16x16x32_bf16 v[116:119], v[228:231], v[40:43], v[116:119]
    ds_read_b128 v[36:39], v19 offset:24832
    v_mfma_f32_16x16x32_bf16 v[120:123], v[228:231], v[44:47], v[120:123]
    ds_read_b128 v[40:43], v19 offset:26624
    s_waitcnt lgkmcnt(5)
    v_mfma_f32_16x16x32_bf16 v[116:119], v[232:235], v[48:51], v[116:119]
    ds_read_b128 v[44:47], v19 offset:26880
    v_mfma_f32_16x16x32_bf16 v[120:123], v[232:235], v[52:55], v[120:123]
    ds_read_b128 v[48:51], v19 offset:28672
    s_waitcnt lgkmcnt(5)
    v_mfma_f32_16x16x32_bf16 v[116:119], v[236:239], v[56:59], v[116:119]
    ds_read_b128 v[52:55], v19 offset:28928
    v_mfma_f32_16x16x32_bf16 v[120:123], v[236:239], v[60:63], v[120:123]
    ds_read_b128 v[56:59], v19 offset:30720
    s_waitcnt lgkmcnt(5)
    v_mfma_f32_16x16x32_bf16 v[116:119], v[240:243], v[32:35], v[116:119]
    ds_read_b128 v[60:63], v19 offset:30976
    v_mfma_f32_16x16x32_bf16 v[120:123], v[240:243], v[36:39], v[120:123]
    s_waitcnt lgkmcnt(4)
    v_mfma_f32_16x16x32_bf16 v[116:119], v[244:247], v[40:43], v[116:119]
    v_mfma_f32_16x16x32_bf16 v[120:123], v[244:247], v[44:47], v[120:123]
    s_waitcnt lgkmcnt(2)
    v_mfma_f32_16x16x32_bf16 v[116:119], v[248:251], v[48:51], v[116:119]
    v_mfma_f32_16x16x32_bf16 v[120:123], v[248:251], v[52:55], v[120:123]
    s_waitcnt lgkmcnt(0)
    v_mfma_f32_16x16x32_bf16 v[116:119], v[252:255], v[56:59], v[116:119]
    v_mfma_f32_16x16x32_bf16 v[120:123], v[252:255], v[60:63], v[120:123]
    s_or_b32 s49, s2, s3
    s_mov_b32 s50, 6291456
    s_nop 5
    v_permlane16_swap_b32 v116, v120
    v_permlane16_swap_b32 v117, v121
    v_permlane16_swap_b32 v118, v122
    v_permlane16_swap_b32 v119, v123
    v_pk_fma_f32 v[116:117], v[116:117], v[104:105], v[96:97]
    v_pk_fma_f32 v[118:119], v[118:119], v[106:107], v[98:99]
    v_pk_fma_f32 v[120:121], v[120:121], v[108:109], v[100:101]
    v_pk_fma_f32 v[122:123], v[122:123], v[110:111], v[102:103]
    v_cvt_pk_bf16_f32 v112, v116, v117
    v_cvt_pk_bf16_f32 v113, v118, v119
    v_cvt_pk_bf16_f32 v114, v120, v121
    v_cvt_pk_bf16_f32 v115, v122, v123
    buffer_store_dwordx4 v[112:115], v2, s[24:27], 0 offen
    s_cmp_lg_u32 s49, 0
    s_cbranch_scc1 L_nononce
    s_mov_b64 exec, 1
    buffer_store_dword v8, v7, s[16:19], s50 offen sc1
L_nononce:
    s_endpgm
L_hint2:
    buffer_load_dword v145, v149, s[16:19], s76 offen sc1
    s_branch L_hint2_ret
L_slowstart:
    s_mov_b32 s54, 24
L_slowh:
    s_waitcnt vmcnt(0)
    v_cmp_ne_u32 vcc, s44, v145
    s_and_b32 s50, s4, 28
    s_lshr_b64 vcc, vcc, s50
    s_mov_b32 s78, vcc_lo
    s_and_b32 vcc_lo, vcc_lo, 0xf
    s_mov_b32 vcc_hi, 0
    s_mov_b64 vcc, vcc
    s_cbranch_vccz L_slowdone
    buffer_load_dword v145, v149, s[16:19], s76 offen sc1
    s_sub_u32 s54, s54, 1
    s_cmp_lg_u32 s54, 0
    s_cbranch_scc1 L_slowh
    s_mov_b32 s54, 65536
L_slowf:
    buffer_load_dword v145, v148, s[16:19], s74 offen sc1
    s_waitcnt vmcnt(0) lgkmcnt(0)
    v_cmp_ne_u32 vcc, s44, v145
    s_and_b32 s50, s4, 28
    s_lshr_b64 vcc, vcc, s50
    s_mov_b32 s78, vcc_lo
    s_and_b32 vcc_lo, vcc_lo, 0xf
    s_mov_b32 vcc_hi, 0
    s_mov_b64 vcc, vcc
    s_cbranch_vccz L_slowf_ok
    s_sub_u32 s54, s54, 1
    s_cmp_eq_u32 s54, 0
    s_cbranch_scc1 L_slowf_ok
    s_sleep 4
    s_branch L_slowf
L_slowf_ok:
    s_nop 1
L_slowdone:
    buffer_load_dwordx4 v[84:87], v11, s[16:19], s53 offen sc1
    s_mov_b64 exec, s[56:57]
    buffer_load_dwordx4 v[88:91], v11, s[16:19], s53 offen offset:1024 sc1
    buffer_load_dwordx4 v[92:95], v11, s[16:19], s53 offen offset:1280 sc1
    s_mov_b64 exec, -1
    buffer_load_dwordx4 v[96:99], v12, s[16:19], s53 offen sc1
    s_mov_b64 exec, s[56:57]
    buffer_load_dwordx4 v[100:103], v12, s[16:19], s53 offen offset:1024 sc1
    buffer_load_dwordx4 v[104:107], v12, s[16:19], s53 offen offset:1280 sc1
    s_mov_b64 exec, -1
    buffer_load_dwordx4 v[108:111], v13, s[16:19], s53 offen sc1
    s_mov_b64 exec, s[56:57]
    buffer_load_dwordx4 v[112:115], v13, s[16:19], s53 offen offset:1024 sc1
    buffer_load_dwordx4 v[116:119], v13, s[16:19], s53 offen offset:1280 sc1
    s_mov_b64 exec, -1
    s_branch L_slowstart_ret
L_latewait:
    s_mov_b32 s54, 65536
L_latewaitp:
    s_mov_b32 s49, 6324224
    v_lshlrev_b32 v146, 3, v21
    buffer_load_dwordx2 v[146:147], v146, s[16:19], s49 offen sc1
    buffer_load_dword v144, v20, s[16:19], s73 offen sc1
    s_waitcnt vmcnt(0) lgkmcnt(0)
    v_cmp_ne_u32 vcc, s44, v144
    v_cmp_ne_u32 s[58:59], s44, v147
    s_nop 0
    s_or_b64 vcc, vcc, s[58:59]
    s_cbranch_vccz L_latewaitp_ok
    s_sub_u32 s54, s54, 1
    s_cmp_eq_u32 s54, 0
    s_cbranch_scc1 L_latewaitp_ok
    s_sleep 4
    s_branch L_latewaitp
L_latewaitp_ok:
    s_nop 1
    s_branch L_latewait_ret
L_ehwait:
    s_mov_b32 s54, 256
L_ehwaitp:
    buffer_load_dword v144, v7, s[16:19], s75 offen sc1
    s_waitcnt vmcnt(0) lgkmcnt(0)
    v_cmp_ne_u32 vcc, s44, v144
    s_nop 0
    s_cbranch_vccz L_ehwaitp_ok
    s_sub_u32 s54, s54, 1
    s_cmp_eq_u32 s54, 0
    s_cbranch_scc1 L_ehwaitp_ok
    s_sleep 3
    s_branch L_ehwaitp
L_ehwaitp_ok:
    s_nop 1
    s_branch L_ehwait_ret
L_guardwait:
    s_mov_b32 s54, 65536
L_guardwaitp:
    ds_read_b32 v27, v26 offset:32
    ds_read_b64 v[182:183], v26
    s_waitcnt lgkmcnt(0)
    v_cmp_gt_u32 vcc, 11, v27
    s_nop 0
    s_cbranch_vccz L_guardwaitp_ok
    s_sub_u32 s54, s54, 1
    s_cmp_eq_u32 s54, 0
    s_cbranch_scc1 L_guardwaitp_ok
    s_sleep 2
    s_branch L_guardwaitp
L_guardwaitp_ok:
    s_nop 1
    s_branch L_guardwait_ret
L_owait:
    s_waitcnt lgkmcnt(0)
    s_mov_b32 s54, 65536
L_owaitp:
    buffer_load_dwordx4 v[150:153], v1, s[16:19], s72 offen offset:0 sc1
    buffer_load_dwordx4 v[154:157], v1, s[16:19], s72 offen offset:1024 sc1
    buffer_load_dwordx4 v[158:161], v1, s[16:19], s72 offen offset:2048 sc1
    buffer_load_dwordx4 v[162:165], v1, s[16:19], s72 offen offset:3072 sc1
    s_waitcnt vmcnt(0) lgkmcnt(0)
    v_max3_u32 v166, v150, v151, v150
    v_max3_u32 v166, v152, v153, v166
    v_max3_u32 v166, v154, v155, v166
    v_max3_u32 v166, v156, v157, v166
    v_max3_u32 v166, v158, v159, v166
    v_max3_u32 v166, v160, v161, v166
    v_max3_u32 v166, v162, v163, v166
    v_max3_u32 v166, v164, v165, v166
    v_cmp_eq_u32 vcc, -1, v166
    s_nop 0
    s_cbranch_vccz L_owaitp_ok
    s_sub_u32 s54, s54, 1
    s_cmp_eq_u32 s54, 0
    s_cbranch_scc1 L_owaitp_ok
    s_sleep 2
    s_branch L_owaitp
L_owaitp_ok:
    s_nop 1
    ds_write_b128 v18, v[150:153] offset:0
    ds_write_b128 v18, v[154:157] offset:1024
    ds_write_b128 v18, v[158:161] offset:2048
    ds_write_b128 v18, v[162:165] offset:3072
    s_branch L_owait_ret
L_cand:
    v_add_u32 v186, 157184, v3
    ds_read_b32 v182, v186
    ds_read_b32 v184, v186 offset:256
    s_lshl_b32 s49, s4, 6
    s_sub_u32 s49, 2047, s49
    v_sub_u32 v187, s49, v0
    v_mov_b32 v183, s44
    v_mov_b32 v185, s44
    s_waitcnt lgkmcnt(0)
    v_ashrrev_i32 v188, 31, v182
    v_or_b32 v188, 0x80000000, v188
    v_xor_b32 v182, v182, v188
    v_and_b32 v182, 0xffff0000, v182
    v_or_b32 v182, v182, v187
    s_barrier
    s_nop 0
    v_max_u32_dpp v190, v182, v182 quad_perm:[1,0,3,2] row_mask:0xf bank_mask:0xf
    s_nop 1
    v_max_u32_dpp v190, v190, v190 quad_perm:[2,3,0,1] row_mask:0xf bank_mask:0xf
    s_nop 1
    v_max_u32_dpp v190, v190, v190 row_half_mirror row_mask:0xf bank_mask:0xf
    s_nop 1
    v_max_u32_dpp v190, v190, v190 row_mirror row_mask:0xf bank_mask:0xf
    s_nop 1
    v_max_u32_dpp v190, v190, v190 row_bcast:15 row_mask:0xa bank_mask:0xf
    s_nop 1
    v_max_u32_dpp v190, v190, v190 row_bcast:31 row_mask:0xc bank_mask:0xf
    s_nop 0
    v_readlane_b32 s62, v190, 63
    s_nop 1
    v_cmp_eq_u32 s[58:59], s62, v182
    s_nop 1
    v_cndmask_b32 v191, v182, 0, s[58:59]
    s_nop 1
    v_max_u32_dpp v190, v191, v191 quad_perm:[1,0,3,2] row_mask:0xf bank_mask:0xf
    s_nop 1
    v_max_u32_dpp v190, v190, v190 quad_perm:[2,3,0,1] row_mask:0xf bank_mask:0xf
    s_nop 1
    v_max_u32_dpp v190, v190, v190 row_half_mirror row_mask:0xf bank_mask:0xf
    s_nop 1
    v_max_u32_dpp v190, v190, v190 row_mirror row_mask:0xf bank_mask:0xf
    s_nop 1
    v_max_u32_dpp v190, v190, v190 row_bcast:15 row_mask:0xa bank_mask:0xf
    s_nop 1
    v_max_u32_dpp v190, v190, v190 row_bcast:31 row_mask:0xc bank_mask:0xf
    s_nop 0
    v_readlane_b32 s63, v190, 63
    s_nop 1
    v_cmp_eq_u32 s[60:61], s63, v182
    s_nop 1
    v_cndmask_b32 v186, 0, 16, s[60:61]
    v_lshlrev_b32 v187, 3, v0
    s_branch L_cand_ret
L_cand2:
    s_lshl_b32 s49, s4, 5
    s_add_u32 s49, s49, 6295552
    s_lshl_b32 s50, s4, 9
    s_add_u32 s50, s50, 6324224
    buffer_store_dwordx2 v[184:185], v187, s[16:19], s50 offen sc1
    s_or_b64 exec, s[58:59], s[60:61]
    buffer_store_dwordx4 v[182:185], v186, s[16:19], s49 offen sc1
    s_mov_b64 exec, -1
    s_branch L_cand2_ret
L_st0:
    s_mov_b32 s62, 6295552
    buffer_load_dwordx4 v[182:185], v1, s[16:19], s62 offen sc1
    v_exp_f32 v150, v150
    v_exp_f32 v151, v151
    v_smfmac_f32_32x32x32_bf16 v[48:63], v[104:107], v[174:181], v6
    v_exp_f32 v152, v152
    v_exp_f32 v153, v153
    v_exp_f32 v154, v154
    v_mfma_f32_32x32x16_bf16 v[166:181], v[108:111], v[68:71], 0
    v_exp_f32 v155, v155
    v_exp_f32 v156, v156
    v_exp_f32 v157, v157
    v_exp_f32 v158, v158
    v_exp_f32 v159, v159
    v_smfmac_f32_32x32x32_bf16 v[32:47], v[112:115], v[150:157], v6
    v_exp_f32 v160, v160
    v_exp_f32 v161, v161
    v_exp_f32 v162, v162
    buffer_load_dwordx4 v[72:75], v12, s[16:19], s53 offen sc1
    s_mov_b64 exec, s[56:57]
    buffer_load_dwordx4 v[76:79], v12, s[16:19], s53 offen offset:1024 sc1
    buffer_load_dwordx4 v[80:83], v12, s[16:19], s53 offen offset:1280 sc1
    s_mov_b64 exec, -1
    v_exp_f32 v163, v163
    v_exp_f32 v164, v164
    v_exp_f32 v165, v165
    v_exp_f32 v166, v166
    v_exp_f32 v167, v167
    v_smfmac_f32_32x32x32_bf16 v[32:47], v[116:119], v[158:165], v6
    v_exp_f32 v168, v168
    v_exp_f32 v169, v169
    v_exp_f32 v170, v170
    s_waitcnt vmcnt(7)
    v_mfma_f32_32x32x16_bf16 v[150:165], v[120:123], v[64:67], 0
    v_exp_f32 v171, v171
    v_exp_f32 v172, v172
    v_exp_f32 v173, v173
    v_exp_f32 v174, v174
    v_exp_f32 v175, v175
    v_smfmac_f32_32x32x32_bf16 v[48:63], v[112:115], v[166:173], v6
    v_exp_f32 v176, v176
    v_exp_f32 v177, v177
    v_exp_f32 v178, v178
    v_exp_f32 v179, v179
    v_exp_f32 v180, v180
    v_exp_f32 v181, v181
    v_exp_f32 v150, v150
    v_exp_f32 v151, v151
    v_smfmac_f32_32x32x32_bf16 v[48:63], v[116:119], v[174:181], v6
    v_exp_f32 v152, v152
    v_exp_f32 v153, v153
    v_exp_f32 v154, v154
    v_mfma_f32_32x32x16_bf16 v[166:181], v[120:123], v[68:71], 0
    v_exp_f32 v155, v155
    v_exp_f32 v156, v156
    v_exp_f32 v157, v157
    v_exp_f32 v158, v158
    v_exp_f32 v159, v159
    v_smfmac_f32_32x32x32_bf16 v[32:47], v[124:127], v[150:157], v6
    v_exp_f32 v160, v160
    v_exp_f32 v161, v161
    v_exp_f32 v162, v162
    buffer_load_dwordx4 v[84:87], v13, s[16:19], s53 offen sc1
    s_mov_b64 exec, s[56:57]
    buffer_load_dwordx4 v[88:91], v13, s[16:19], s53 offen offset:1024 sc1
    buffer_load_dwordx4 v[92:95], v13, s[16:19], s53 offen offset:1280 sc1
    s_mov_b64 exec, -1
    v_exp_f32 v163, v163
    v_exp_f32 v164, v164
    v_exp_f32 v165, v165
    v_exp_f32 v166, v166
    v_exp_f32 v167, v167
    v_smfmac_f32_32x32x32_bf16 v[32:47], v[128:131], v[158:165], v6
    v_exp_f32 v168, v168
    v_exp_f32 v169, v169
    v_exp_f32 v170, v170
    s_waitcnt vmcnt(7)
    v_mfma_f32_32x32x16_bf16 v[150:165], v[132:135], v[64:67], 0
    v_exp_f32 v171, v171
    v_exp_f32 v172, v172
    v_exp_f32 v173, v173
    v_exp_f32 v174, v174
    v_exp_f32 v175, v175
    v_smfmac_f32_32x32x32_bf16 v[48:63], v[124:127], v[166:173], v6
    v_exp_f32 v176, v176
    v_exp_f32 v177, v177
    v_exp_f32 v178, v178
    v_exp_f32 v179, v179
    v_exp_f32 v180, v180
    v_exp_f32 v181, v181
    v_exp_f32 v150, v150
    v_exp_f32 v151, v151
    v_smfmac_f32_32x32x32_bf16 v[48:63], v[128:131], v[174:181], v6
    v_exp_f32 v152, v152
    v_exp_f32 v153, v153
    v_exp_f32 v154, v154
    v_mfma_f32_32x32x16_bf16 v[166:181], v[132:135], v[68:71], 0
    v_exp_f32 v155, v155
    v_exp_f32 v156, v156
    v_exp_f32 v157, v157
    v_exp_f32 v158, v158
    v_exp_f32 v159, v159
    v_smfmac_f32_32x32x32_bf16 v[32:47], v[136:139], v[150:157], v6
    v_exp_f32 v160, v160
    v_exp_f32 v161, v161
    v_exp_f32 v162, v162
    s_and_b32 s49, s78, 0xf00
    s_cbranch_scc1 L_grp2_r0
L_grp2_r0_ret:
    s_add_u32 s53, s53, 0x10000
    s_and_b32 s53, s53, 0x7ffff
    buffer_load_dwordx4 v[96:99], v10, s[16:19], s53 offen sc1
    s_mov_b64 exec, s[56:57]
    buffer_load_dwordx4 v[100:103], v10, s[16:19], s53 offen offset:1024 sc1
    buffer_load_dwordx4 v[104:107], v10, s[16:19], s53 offen offset:1280 sc1
    s_mov_b64 exec, -1
    v_exp_f32 v163, v163
    v_exp_f32 v164, v164
    v_exp_f32 v165, v165
    v_exp_f32 v166, v166
    v_exp_f32 v167, v167
    v_smfmac_f32_32x32x32_bf16 v[32:47], v[140:143], v[158:165], v6
    v_exp_f32 v168, v168
    v_exp_f32 v169, v169
    v_exp_f32 v170, v170
    s_waitcnt vmcnt(6)
    v_mfma_f32_32x32x16_bf16 v[150:165], v[72:75], v[64:67], 0
    v_exp_f32 v171, v171
    v_exp_f32 v172, v172
    v_exp_f32 v173, v173
    v_exp_f32 v174, v174
    v_exp_f32 v175, v175
    v_smfmac_f32_32x32x32_bf16 v[48:63], v[136:139], v[166:173], v6
    v_exp_f32 v176, v176
    v_exp_f32 v177, v177
    v_exp_f32 v178, v178
    v_exp_f32 v179, v179
    v_exp_f32 v180, v180
    v_exp_f32 v181, v181
    v_cmp_ne_u32 vcc, s44, v183
    v_cmp_ne_u32 s[58:59], s44, v185
    s_nop 0
    s_or_b64 vcc, vcc, s[58:59]
    s_cbranch_vccz L_candpoll_done
    s_mov_b32 s54, 65536
L_candpoll:
    buffer_load_dwordx4 v[182:185], v1, s[16:19], s62 offen sc1
    s_waitcnt vmcnt(0) lgkmcnt(0)
    v_cmp_ne_u32 vcc, s44, v183
    v_cmp_ne_u32 s[58:59], s44, v185
    s_nop 0
    s_or_b64 vcc, vcc, s[58:59]
    s_cbranch_vccz L_candpoll_ok
    s_sub_u32 s54, s54, 1
    s_cmp_eq_u32 s54, 0
    s_cbranch_scc1 L_candpoll_ok
    s_sleep 4
    s_branch L_candpoll
L_candpoll_ok:
    s_nop 1
L_candpoll_done:
    v_max_u32_dpp v190, v182, v182 quad_perm:[1,0,3,2] row_mask:0xf bank_mask:0xf
    s_nop 1
    v_max_u32_dpp v190, v190, v190 quad_perm:[2,3,0,1] row_mask:0xf bank_mask:0xf
    s_nop 1
    v_max_u32_dpp v190, v190, v190 row_half_mirror row_mask:0xf bank_mask:0xf
    s_nop 1
    v_max_u32_dpp v190, v190, v190 row_mirror row_mask:0xf bank_mask:0xf
    s_nop 1
    v_max_u32_dpp v190, v190, v190 row_bcast:15 row_mask:0xa bank_mask:0xf
    s_nop 1
    v_max_u32_dpp v190, v190, v190 row_bcast:31 row_mask:0xc bank_mask:0xf
    s_nop 0
    v_readlane_b32 s62, v190, 63
    s_nop 1
    v_cmp_eq_u32 s[58:59], s62, v182
    s_nop 1
    v_cndmask_b32 v191, v182, 0, s[58:59]
    s_nop 1
    v_max_u32_dpp v190, v191, v191 quad_perm:[1,0,3,2] row_mask:0xf bank_mask:0xf
    s_nop 1
    v_max_u32_dpp v190, v190, v190 quad_perm:[2,3,0,1] row_mask:0xf bank_mask:0xf
    s_nop 1
    v_max_u32_dpp v190, v190, v190 row_half_mirror row_mask:0xf bank_mask:0xf
    s_nop 1
    v_max_u32_dpp v190, v190, v190 row_mirror row_mask:0xf bank_mask:0xf
    s_nop 1
    v_max_u32_dpp v190, v190, v190 row_bcast:15 row_mask:0xa bank_mask:0xf
    s_nop 1
    v_max_u32_dpp v190, v190, v190 row_bcast:31 row_mask:0xc bank_mask:0xf
    s_nop 0
    v_readlane_b32 s63, v190, 63
    s_nop 1
    v_cmp_eq_u32 s[60:61], s63, v182
    s_ff1_i32_b64 s64, s[58:59]
    s_ff1_i32_b64 s65, s[60:61]
    s_and_b32 s64, s64, 63
    s_and_b32 s65, s65, 63
    v_readlane_b32 s64, v184, s64
    v_readlane_b32 s65, v184, s65
    s_and_b32 s66, s62, 2047
    s_sub_u32 s66, 2047, s66
    s_and_b32 s67, s63, 2047
    s_sub_u32 s67, 2047, s67
    v_add_u32 v183, 157696, v3
    v_mov_b32 v182, 1
    v_writelane_b32 v182, s66, 0
    v_writelane_b32 v182, s67, 1
    v_writelane_b32 v182, s64, 2
    v_writelane_b32 v182, s65, 3
    v_writelane_b32 v182, s62, 4
    v_writelane_b32 v182, s63, 5
    s_mov_b64 exec, 0x3f
    ds_write_b32 v183, v182
    s_waitcnt lgkmcnt(0)
    s_mov_b64 exec, 0x40
    ds_write_b32 v183, v182
    ds_add_u32 v183, v182 offset:8
    s_mov_b64 exec, -1
    s_branch L_st0_ret
L_st1:
    s_cmp_lt_u32 s1, 28
    s_cbranch_scc1 L_st1_go
    v_mov_b32 v188, 1
    v_mov_b32 v189, 157696
    s_mov_b64 exec, 1
    ds_add_u32 v189, v188 offset:32
    s_mov_b64 exec, -1
    s_branch L_st1_skip
L_st1_go:
    s_mul_i32 s80, s0, 229376
    s_lshl_b32 s62, s1, 7
    s_add_u32 s80, s80, s62
    s_cmp_eq_u32 s3, 3
    s_cselect_b64 s[28:29], s[32:33], s[28:29]
    v_exp_f32 v150, v150
    v_exp_f32 v151, v151
    v_smfmac_f32_32x32x32_bf16 v[48:63], v[104:107], v[174:181], v6
    v_exp_f32 v152, v152
    v_exp_f32 v153, v153
    v_exp_f32 v154, v154
    v_mfma_f32_32x32x16_bf16 v[166:181], v[108:111], v[68:71], 0
    v_exp_f32 v155, v155
    v_exp_f32 v156, v156
    v_exp_f32 v157, v157
    v_exp_f32 v158, v158
    v_exp_f32 v159, v159
    v_smfmac_f32_32x32x32_bf16 v[32:47], v[112:115], v[150:157], v6
    v_exp_f32 v160, v160
    v_exp_f32 v161, v161
    v_exp_f32 v162, v162
    buffer_load_dwordx4 v[72:75], v12, s[16:19], s53 offen sc1
    s_mov_b64 exec, s[56:57]
    buffer_load_dwordx4 v[76:79], v12, s[16:19], s53 offen offset:1024 sc1
    buffer_load_dwordx4 v[80:83], v12, s[16:19], s53 offen offset:1280 sc1
    s_mov_b64 exec, -1
    v_exp_f32 v163, v163
    v_exp_f32 v164, v164
    v_exp_f32 v165, v165
    v_exp_f32 v166, v166
    v_exp_f32 v167, v167
    v_smfmac_f32_32x32x32_bf16 v[32:47], v[116:119], v[158:165], v6
    v_exp_f32 v168, v168
    v_exp_f32 v169, v169
    v_exp_f32 v170, v170
    s_waitcnt vmcnt(6)
    v_mfma_f32_32x32x16_bf16 v[150:165], v[120:123], v[64:67], 0
    v_exp_f32 v171, v171
    v_exp_f32 v172, v172
    v_exp_f32 v173, v173
    v_exp_f32 v174, v174
    v_exp_f32 v175, v175
    v_smfmac_f32_32x32x32_bf16 v[48:63], v[112:115], v[166:173], v6
    v_exp_f32 v176, v176
    v_exp_f32 v177, v177
    v_exp_f32 v178, v178
    s_add_u32 m0, s81, 0
    s_add_u32 s49, s80, 0
    buffer_load_dwordx4 v23, s[28:31], s49 offen nt lds
    s_add_u32 m0, s81, 1024
    s_add_u32 s49, s80, 28672
    buffer_load_dwordx4 v24, s[28:31], s49 offen nt lds
    v_exp_f32 v179, v179
    v_exp_f32 v180, v180
    v_exp_f32 v181, v181
    v_exp_f32 v150, v150
    v_exp_f32 v151, v151
    v_smfmac_f32_32x32x32_bf16 v[48:63], v[116:119], v[174:181], v6
    v_exp_f32 v152, v152
    v_exp_f32 v153, v153
    v_exp_f32 v154, v154
    v_mfma_f32_32x32x16_bf16 v[166:181], v[120:123], v[68:71], 0
    v_exp_f32 v155, v155
    v_exp_f32 v156, v156
    v_exp_f32 v157, v157
    v_exp_f32 v158, v158
    v_exp_f32 v159, v159
    v_smfmac_f32_32x32x32_bf16 v[32:47], v[124:127], v[150:157], v6
    v_exp_f32 v160, v160
    v_exp_f32 v161, v161
    v_exp_f32 v162, v162
    buffer_load_dwordx4 v[84:87], v13, s[16:19], s53 offen sc1
    s_mov_b64 exec, s[56:57]
    buffer_load_dwordx4 v[88:91], v13, s[16:19], s53 offen offset:1024 sc1
    buffer_load_dwordx4 v[92:95], v13, s[16:19], s53 offen offset:1280 sc1
    s_mov_b64 exec, -1
    v_exp_f32 v163, v163
    v_exp_f32 v164, v164
    v_exp_f32 v165, v165
    v_exp_f32 v166, v166
    v_exp_f32 v167, v167
    v_smfmac_f32_32x32x32_bf16 v[32:47], v[128:131], v[158:165], v6
    v_exp_f32 v168, v168
    v_exp_f32 v169, v169
    v_exp_f32 v170, v170
    s_waitcnt vmcnt(8)
    v_mfma_f32_32x32x16_bf16 v[150:165], v[132:135], v[64:67], 0
    v_exp_f32 v171, v171
    v_exp_f32 v172, v172
    v_exp_f32 v173, v173
    v_exp_f32 v174, v174
    v_exp_f32 v175, v175
    v_smfmac_f32_32x32x32_bf16 v[48:63], v[124:127], v[166:173], v6
    v_exp_f32 v176, v176
    v_exp_f32 v177, v177
    v_exp_f32 v178, v178
    s_add_u32 m0, s81, 2048
    s_add_u32 s49, s80, 57344
    buffer_load_dwordx4 v23, s[28:31], s49 offen nt lds
    s_add_u32 m0, s81, 3072
    s_add_u32 s49, s80, 86016
    buffer_load_dwordx4 v24, s[28:31], s49 offen nt lds
    v_exp_f32 v179, v179
    v_exp_f32 v180, v180
    v_exp_f32 v181, v181
    v_exp_f32 v150, v150
    v_exp_f32 v151, v151
    v_smfmac_f32_32x32x32_bf16 v[48:63], v[128:131], v[174:181], v6
    v_exp_f32 v152, v152
    v_exp_f32 v153, v153
    v_exp_f32 v154, v154
    v_mfma_f32_32x32x16_bf16 v[166:181], v[132:135], v[68:71], 0
    v_exp_f32 v155, v155
    v_exp_f32 v156, v156
    v_exp_f32 v157, v157
    v_exp_f32 v158, v158
    v_exp_f32 v159, v159
    v_smfmac_f32_32x32x32_bf16 v[32:47], v[136:139], v[150:157], v6
    v_exp_f32 v160, v160
    v_exp_f32 v161, v161
    v_exp_f32 v162, v162
    s_and_b32 s49, s78, 0xf00
    s_cbranch_scc1 L_grp2_r1
L_grp2_r1_ret:
    s_add_u32 s53, s53, 0x10000
    s_and_b32 s53, s53, 0x7ffff
    buffer_load_dwordx4 v[96:99], v10, s[16:19], s53 offen sc1
    s_mov_b64 exec, s[56:57]
    buffer_load_dwordx4 v[100:103], v10, s[16:19], s53 offen offset:1024 sc1
    buffer_load_dwordx4 v[104:107], v10, s[16:19], s53 offen offset:1280 sc1
    s_mov_b64 exec, -1
    v_exp_f32 v163, v163
    v_exp_f32 v164, v164
    v_exp_f32 v165, v165
    v_exp_f32 v166, v166
    v_exp_f32 v167, v167
    v_smfmac_f32_32x32x32_bf16 v[32:47], v[140:143], v[158:165], v6
    v_exp_f32 v168, v168
    v_exp_f32 v169, v169
    v_exp_f32 v170, v170
    s_waitcnt vmcnt(10)
    v_mfma_f32_32x32x16_bf16 v[150:165], v[72:75], v[64:67], 0
    v_exp_f32 v171, v171
    v_exp_f32 v172, v172
    v_exp_f32 v173, v173
    v_exp_f32 v174, v174
    v_exp_f32 v175, v175
    v_smfmac_f32_32x32x32_bf16 v[48:63], v[136:139], v[166:173], v6
    v_exp_f32 v176, v176
    v_exp_f32 v177, v177
    v_exp_f32 v178, v178
    s_add_u32 m0, s81, 4096
    s_add_u32 s49, s80, 114688
    buffer_load_dwordx4 v23, s[28:31], s49 offen nt lds
    s_add_u32 m0, s81, 5120
    s_add_u32 s49, s80, 143360
    buffer_load_dwordx4 v24, s[28:31], s49 offen nt lds
    v_exp_f32 v179, v179
    v_exp_f32 v180, v180
    v_exp_f32 v181, v181
    v_exp_f32 v150, v150
    v_exp_f32 v151, v151
    v_smfmac_f32_32x32x32_bf16 v[48:63], v[140:143], v[174:181], v6
    v_exp_f32 v152, v152
    v_exp_f32 v153, v153
    v_exp_f32 v154, v154
    v_mfma_f32_32x32x16_bf16 v[166:181], v[72:75], v[68:71], 0
    v_exp_f32 v155, v155
    v_exp_f32 v156, v156
    v_exp_f32 v157, v157
    v_exp_f32 v158, v158
    v_exp_f32 v159, v159
    v_smfmac_f32_32x32x32_bf16 v[32:47], v[76:79], v[150:157], v6
    v_exp_f32 v160, v160
    v_exp_f32 v161, v161
    v_exp_f32 v162, v162
    buffer_load_dwordx4 v[108:111], v11, s[16:19], s53 offen sc1
    s_mov_b64 exec, s[56:57]
    buffer_load_dwordx4 v[112:115], v11, s[16:19], s53 offen offset:1024 sc1
    buffer_load_dwordx4 v[116:119], v11, s[16:19], s53 offen offset:1280 sc1
    s_mov_b64 exec, -1
    v_exp_f32 v163, v163
    v_exp_f32 v164, v164
    v_exp_f32 v165, v165
    v_exp_f32 v166, v166
    v_exp_f32 v167, v167
    v_smfmac_f32_32x32x32_bf16 v[32:47], v[80:83], v[158:165], v6
    v_exp_f32 v168, v168
    v_exp_f32 v169, v169
    v_exp_f32 v170, v170
    s_waitcnt vmcnt(10)
    v_mfma_f32_32x32x16_bf16 v[150:165], v[84:87], v[64:67], 0
    v_exp_f32 v171, v171
    v_exp_f32 v172, v172
    v_exp_f32 v173, v173
    v_exp_f32 v174, v174
    v_exp_f32 v175, v175
    v_smfmac_f32_32x32x32_bf16 v[48:63], v[76:79], v[166:173], v6
    v_exp_f32 v176, v176
    v_exp_f32 v177, v177
    v_exp_f32 v178, v178
    s_add_u32 m0, s81, 6144
    s_add_u32 s49, s80, 172032
    buffer_load_dwordx4 v23, s[28:31], s49 offen nt lds
    s_add_u32 m0, s81, 7168
    s_add_u32 s49, s80, 200704
    buffer_load_dwordx4 v24, s[28:31], s49 offen nt lds
    v_exp_f32 v179, v179
    v_exp_f32 v180, v180
    v_exp_f32 v181, v181
    v_exp_f32 v150, v150
    v_exp_f32 v151, v151
    v_smfmac_f32_32x32x32_bf16 v[48:63], v[80:83], v[174:181], v6
    v_exp_f32 v152, v152
    v_exp_f32 v153, v153
    v_exp_f32 v154, v154
    v_mfma_f32_32x32x16_bf16 v[166:181], v[84:87], v[68:71], 0
    v_exp_f32 v155, v155
    v_exp_f32 v156, v156
    v_exp_f32 v157, v157
    v_exp_f32 v158, v158
    v_exp_f32 v159, v159
    v_smfmac_f32_32x32x32_bf16 v[32:47], v[88:91], v[150:157], v6
    v_exp_f32 v160, v160
    v_exp_f32 v161, v161
    v_exp_f32 v162, v162
    buffer_load_dwordx4 v[120:123], v12, s[16:19], s53 offen sc1
    s_mov_b64 exec, s[56:57]
    buffer_load_dwordx4 v[124:127], v12, s[16:19], s53 offen offset:1024 sc1
    buffer_load_dwordx4 v[128:131], v12, s[16:19], s53 offen offset:1280 sc1
    s_mov_b64 exec, -1
    v_exp_f32 v163, v163
    v_exp_f32 v164, v164
    v_exp_f32 v165, v165
    v_exp_f32 v166, v166
    v_exp_f32 v167, v167
    v_smfmac_f32_32x32x32_bf16 v[32:47], v[92:95], v[158:165], v6
    v_exp_f32 v168, v168
    v_exp_f32 v169, v169
    v_exp_f32 v170, v170
    s_waitcnt vmcnt(10)
    v_mfma_f32_32x32x16_bf16 v[150:165], v[96:99], v[64:67], 0
    v_exp_f32 v171, v171
    v_exp_f32 v172, v172
    v_exp_f32 v173, v173
    v_exp_f32 v174, v174
    v_exp_f32 v175, v175
    v_smfmac_f32_32x32x32_bf16 v[48:63], v[88:91], v[166:173], v6
    v_exp_f32 v176, v176
    v_exp_f32 v177, v177
    v_exp_f32 v178, v178
    v_exp_f32 v179, v179
    v_exp_f32 v180, v180
    v_exp_f32 v181, v181
    v_mov_b32 v192, 0x3f803f80
    v_mov_b32 v193, 0x3f803f80
    v_mov_b32 v194, 0x3f803f80
    v_mov_b32 v195, 0x3f803f80
    v_mov_b32 v196, 0x3f803f80
    v_mov_b32 v197, 0x3f803f80
    v_mov_b32 v198, 0x3f803f80
    v_mov_b32 v199, 0x3f803f80
    v_mov_b32 v189, 157696
    s_mov_b32 s54, 65536
L_selpoll1:
    ds_read_b32 v188, v189 offset:24
    s_waitcnt lgkmcnt(0)
    v_cmp_eq_u32 vcc, 0, v188
    s_nop 0
    s_cbranch_vccz L_selpoll1_ok
    s_sub_u32 s54, s54, 1
    s_cmp_eq_u32 s54, 0
    s_cbranch_scc1 L_selpoll1_ok
    s_sleep 2
    s_branch L_selpoll1
L_selpoll1_ok:
    s_nop 1
    ds_read_b128 v[182:185], v189
    ds_read_b64 v[186:187], v189 offset:16
    s_waitcnt lgkmcnt(0)
    v_cndmask_b32 v182, v182, v183, s[82:83]
    v_and_b32 v183, 48, v0
    v_lshl_add_u32 v183, v182, 10, v183
    s_lshl_b32 s62, s0, 7
    s_mov_b32 exec_lo, 0x33333333
    s_mov_b32 exec_hi, 0x33333333
    buffer_load_dwordx4 v[192:195], v183, s[8:11], s62 offen
    buffer_load_dwordx4 v[196:199], v183, s[8:11], s62 offen offset:64
    s_mov_b64 exec, -1
    v_and_b32 v186, 0xffff0000, v184
    v_lshlrev_b32 v184, 16, v184
    v_rcp_f32 v186, v186
    v_and_b32 v187, 0xffff0000, v185
    v_lshlrev_b32 v185, 16, v185
    v_rcp_f32 v187, v187
    v_exp_f32 v150, v150
    v_exp_f32 v151, v151
    v_smfmac_f32_32x32x32_bf16 v[48:63], v[92:95], v[174:181], v6
    v_exp_f32 v152, v152
    v_exp_f32 v153, v153
    v_exp_f32 v154, v154
    v_mfma_f32_32x32x16_bf16 v[166:181], v[96:99], v[68:71], 0
    v_exp_f32 v155, v155
    v_exp_f32 v156, v156
    v_exp_f32 v157, v157
    v_exp_f32 v158, v158
    v_exp_f32 v159, v159
    v_smfmac_f32_32x32x32_bf16 v[32:47], v[100:103], v[150:157], v6
    v_exp_f32 v160, v160
    v_exp_f32 v161, v161
    v_exp_f32 v162, v162
    buffer_load_dwordx4 v[132:135], v13, s[16:19], s53 offen sc1
    s_mov_b64 exec, s[56:57]
    buffer_load_dwordx4 v[136:139], v13, s[16:19], s53 offen offset:1024 sc1
    buffer_load_dwordx4 v[140:143], v13, s[16:19], s53 offen offset:1280 sc1
    s_mov_b64 exec, -1
    v_exp_f32 v163, v163
    v_exp_f32 v164, v164
    v_exp_f32 v165, v165
    v_exp_f32 v166, v166
    v_exp_f32 v167, v167
    v_smfmac_f32_32x32x32_bf16 v[32:47], v[104:107], v[158:165], v6
    v_exp_f32 v168, v168
    v_exp_f32 v169, v169
    v_exp_f32 v170, v170
    s_waitcnt vmcnt(10)
    v_mfma_f32_32x32x16_bf16 v[150:165], v[108:111], v[64:67], 0
    v_exp_f32 v171, v171
    v_exp_f32 v172, v172
    v_exp_f32 v173, v173
    v_exp_f32 v174, v174
    v_exp_f32 v175, v175
    v_smfmac_f32_32x32x32_bf16 v[48:63], v[100:103], v[166:173], v6
    v_exp_f32 v176, v176
    v_exp_f32 v177, v177
    v_exp_f32 v178, v178
    v_exp_f32 v179, v179
    v_exp_f32 v180, v180
    v_exp_f32 v181, v181
    v_exp_f32 v150, v150
    v_exp_f32 v151, v151
    v_smfmac_f32_32x32x32_bf16 v[48:63], v[104:107], v[174:181], v6
    v_exp_f32 v152, v152
    v_exp_f32 v153, v153
    v_exp_f32 v154, v154
    v_mfma_f32_32x32x16_bf16 v[166:181], v[108:111], v[68:71], 0
    v_exp_f32 v155, v155
    v_exp_f32 v156, v156
    v_exp_f32 v157, v157
    v_exp_f32 v158, v158
    v_exp_f32 v159, v159
    v_smfmac_f32_32x32x32_bf16 v[32:47], v[112:115], v[150:157], v6
    v_exp_f32 v160, v160
    v_exp_f32 v161, v161
    v_exp_f32 v162, v162
    s_and_b32 s49, s78, 0xf000
    s_cbranch_scc1 L_grp3_r1
L_grp3_r1_ret:
    s_add_u32 s53, s53, 0x10000
    s_and_b32 s53, s53, 0x7ffff
    buffer_load_dwordx4 v[72:75], v10, s[16:19], s53 offen sc1
    s_mov_b64 exec, s[56:57]
    buffer_load_dwordx4 v[76:79], v10, s[16:19], s53 offen offset:1024 sc1
    buffer_load_dwordx4 v[80:83], v10, s[16:19], s53 offen offset:1280 sc1
    s_mov_b64 exec, -1
    v_exp_f32 v163, v163
    v_exp_f32 v164, v164
    v_exp_f32 v165, v165
    v_exp_f32 v166, v166
    v_exp_f32 v167, v167
    v_smfmac_f32_32x32x32_bf16 v[32:47], v[116:119], v[158:165], v6
    v_exp_f32 v168, v168
    v_exp_f32 v169, v169
    v_exp_f32 v170, v170
    s_waitcnt vmcnt(8)
    v_mfma_f32_32x32x16_bf16 v[150:165], v[120:123], v[64:67], 0
    v_exp_f32 v171, v171
    v_exp_f32 v172, v172
    v_exp_f32 v173, v173
    v_exp_f32 v174, v174
    v_exp_f32 v175, v175
    v_smfmac_f32_32x32x32_bf16 v[48:63], v[112:115], v[166:173], v6
    v_exp_f32 v176, v176
    v_exp_f32 v177, v177
    v_exp_f32 v178, v178
    s_add_u32 m0, s45, 0
    s_mov_b32 s49, 0
    buffer_load_dwordx4 v5, s[20:23], s49 offen lds
    v_exp_f32 v179, v179
    v_exp_f32 v180, v180
    v_exp_f32 v181, v181
    v_exp_f32 v150, v150
    v_exp_f32 v151, v151
    v_smfmac_f32_32x32x32_bf16 v[48:63], v[116:119], v[174:181], v6
    v_exp_f32 v152, v152
    v_exp_f32 v153, v153
    v_exp_f32 v154, v154
    v_mfma_f32_32x32x16_bf16 v[166:181], v[120:123], v[68:71], 0
    v_exp_f32 v155, v155
    v_exp_f32 v156, v156
    v_exp_f32 v157, v157
    v_exp_f32 v158, v158
    v_exp_f32 v159, v159
    v_smfmac_f32_32x32x32_bf16 v[32:47], v[124:127], v[150:157], v6
    v_exp_f32 v160, v160
    v_exp_f32 v161, v161
    v_exp_f32 v162, v162
    buffer_load_dwordx4 v[84:87], v11, s[16:19], s53 offen sc1
    s_mov_b64 exec, s[56:57]
    buffer_load_dwordx4 v[88:91], v11, s[16:19], s53 offen offset:1024 sc1
    buffer_load_dwordx4 v[92:95], v11, s[16:19], s53 offen offset:1280 sc1
    s_mov_b64 exec, -1
    v_exp_f32 v163, v163
    v_exp_f32 v164, v164
    v_exp_f32 v165, v165
    v_exp_f32 v166, v166
    v_exp_f32 v167, v167
    v_smfmac_f32_32x32x32_bf16 v[32:47], v[128:131], v[158:165], v6
    v_exp_f32 v168, v168
    v_exp_f32 v169, v169
    v_exp_f32 v170, v170
    s_waitcnt vmcnt(7)
    v_mfma_f32_32x32x16_bf16 v[150:165], v[132:135], v[64:67], 0
    v_exp_f32 v171, v171
    v_exp_f32 v172, v172
    v_exp_f32 v173, v173
    v_exp_f32 v174, v174
    v_exp_f32 v175, v175
    v_smfmac_f32_32x32x32_bf16 v[48:63], v[124:127], v[166:173], v6
    v_exp_f32 v176, v176
    v_exp_f32 v177, v177
    v_exp_f32 v178, v178
    s_add_u32 m0, s45, 8192
    s_mov_b32 s49, 65536
    buffer_load_dwordx4 v5, s[20:23], s49 offen lds
    v_exp_f32 v179, v179
    v_exp_f32 v180, v180
    v_exp_f32 v181, v181
    ds_read_b64_tr_b16 v[200:201], v252 offset:0
    ds_read_b64_tr_b16 v[202:203], v252 offset:512
    ds_read_b64_tr_b16 v[204:205], v252 offset:4096
    ds_read_b64_tr_b16 v[206:207], v252 offset:4608
    ds_read_b64_tr_b16 v[208:209], v253 offset:0
    ds_read_b64_tr_b16 v[210:211], v253 offset:512
    ds_read_b64_tr_b16 v[212:213], v253 offset:4096
    ds_read_b64_tr_b16 v[214:215], v253 offset:4608
    ds_read_b64_tr_b16 v[216:217], v254 offset:0
    ds_read_b64_tr_b16 v[218:219], v254 offset:512
    ds_read_b64_tr_b16 v[220:221], v254 offset:4096
    ds_read_b64_tr_b16 v[222:223], v254 offset:4608
    ds_read_b64_tr_b16 v[224:225], v255 offset:0
    ds_read_b64_tr_b16 v[226:227], v255 offset:512
    ds_read_b64_tr_b16 v[228:229], v255 offset:4096
    ds_read_b64_tr_b16 v[230:231], v255 offset:4608
    s_lshl_b32 s63, s1, 3
    s_add_u32 s63, s63, s0
    s_lshl_b32 s63, s63, 1
    s_lshr_b32 s64, s3, 1
    s_add_u32 s63, s63, s64
    s_and_b32 s62, s63, 15
    s_lshl_b32 s64, s1, 5
    s_add_u32 s62, s62, s64
    s_lshl_b32 s62, s62, 2
    s_add_u32 s62, s62, 6303744
    s_lshl_b32 s64, s63, 7
    s_add_u32 s64, s64, 6422528
    s_lshl_b32 s63, s63, 9
    s_add_u32 s63, s63, 6815744
    v_lshlrev_b32 v182, 3, v0
    s_waitcnt lgkmcnt(0)
    v_mfma_f32_16x16x32_bf16 v[232:235], v[192:195], v[200:203], 0
    v_mfma_f32_16x16x32_bf16 v[236:239], v[192:195], v[208:211], 0
    v_mfma_f32_16x16x32_bf16 v[240:243], v[192:195], v[216:219], 0
    v_mfma_f32_16x16x32_bf16 v[244:247], v[192:195], v[224:227], 0
    v_mfma_f32_16x16x32_bf16 v[232:235], v[196:199], v[204:207], v[232:235]
    v_mfma_f32_16x16x32_bf16 v[236:239], v[196:199], v[212:215], v[236:239]
    v_mfma_f32_16x16x32_bf16 v[240:243], v[196:199], v[220:223], v[240:243]
    v_mfma_f32_16x16x32_bf16 v[244:247], v[196:199], v[228:231], v[244:247]
    v_mov_b32 v188, 1
    v_mov_b32 v189, 157696
    s_mov_b64 exec, 1
    ds_add_u32 v189, v188 offset:32
    s_mov_b64 exec, -1
    s_lshl_b64 exec, exec, 16
    v_mov_b32 v232, v236
    v_mov_b32 v233, v237
    v_mov_b32 v234, v238
    s_lshl_b64 exec, exec, 16
    v_mov_b32 v232, v240
    v_mov_b32 v233, v241
    v_mov_b32 v234, v242
    s_lshl_b64 exec, exec, 16
    v_mov_b32 v232, v244
    v_mov_b32 v233, v245
    v_mov_b32 v234, v246
    s_mov_b64 exec, -1
    v_fma_f32 v232, -v184, v234, v232
    v_fma_f32 v233, -v185, v234, v233
    v_mul_f32 v232, v186, v232
    v_mul_f32 v233, v187, v233
    buffer_store_dwordx2 v[232:233], v182, s[16:19], s63 offen sc1
    v_exp_f32 v150, v150
    v_exp_f32 v151, v151
    v_smfmac_f32_32x32x32_bf16 v[48:63], v[128:131], v[174:181], v6
    v_exp_f32 v152, v152
    v_exp_f32 v153, v153
    v_exp_f32 v154, v154
    v_mfma_f32_32x32x16_bf16 v[166:181], v[132:135], v[68:71], 0
    v_exp_f32 v155, v155
    v_exp_f32 v156, v156
    v_exp_f32 v157, v157
    v_exp_f32 v158, v158
    v_exp_f32 v159, v159
    v_smfmac_f32_32x32x32_bf16 v[32:47], v[136:139], v[150:157], v6
    v_exp_f32 v160, v160
    v_exp_f32 v161, v161
    v_exp_f32 v162, v162
    buffer_load_dwordx4 v[96:99], v12, s[16:19], s53 offen sc1
    s_mov_b64 exec, s[56:57]
    buffer_load_dwordx4 v[100:103], v12, s[16:19], s53 offen offset:1024 sc1
    buffer_load_dwordx4 v[104:107], v12, s[16:19], s53 offen offset:1280 sc1
    s_mov_b64 exec, -1
    v_exp_f32 v163, v163
    v_exp_f32 v164, v164
    v_exp_f32 v165, v165
    v_exp_f32 v166, v166
    v_exp_f32 v167, v167
    v_smfmac_f32_32x32x32_bf16 v[32:47], v[140:143], v[158:165], v6
    v_exp_f32 v168, v168
    v_exp_f32 v169, v169
    v_exp_f32 v170, v170
    s_waitcnt vmcnt(9)
    v_mfma_f32_32x32x16_bf16 v[150:165], v[72:75], v[64:67], 0
    v_exp_f32 v171, v171
    v_exp_f32 v172, v172
    v_exp_f32 v173, v173
    v_exp_f32 v174, v174
    v_exp_f32 v175, v175
    v_smfmac_f32_32x32x32_bf16 v[48:63], v[136:139], v[166:173], v6
    v_exp_f32 v176, v176
    v_exp_f32 v177, v177
    v_exp_f32 v178, v178
    s_add_u32 m0, s45, 16384
    s_mov_b32 s49, 131072
    buffer_load_dwordx4 v5, s[20:23], s49 offen lds
    v_exp_f32 v179, v179
    v_exp_f32 v180, v180
    v_exp_f32 v181, v181
    v_exp_f32 v150, v150
    v_exp_f32 v151, v151
    v_smfmac_f32_32x32x32_bf16 v[48:63], v[140:143], v[174:181], v6
    v_exp_f32 v152, v152
    v_exp_f32 v153, v153
    v_exp_f32 v154, v154
    v_mfma_f32_32x32x16_bf16 v[166:181], v[72:75], v[68:71], 0
    v_exp_f32 v155, v155
    v_exp_f32 v156, v156
    v_exp_f32 v157, v157
    v_exp_f32 v158, v158
    v_exp_f32 v159, v159
    v_smfmac_f32_32x32x32_bf16 v[32:47], v[76:79], v[150:157], v6
    v_exp_f32 v160, v160
    v_exp_f32 v161, v161
    v_exp_f32 v162, v162
    buffer_load_dwordx4 v[108:111], v13, s[16:19], s53 offen sc1
    s_mov_b64 exec, s[56:57]
    buffer_load_dwordx4 v[112:115], v13, s[16:19], s53 offen offset:1024 sc1
    buffer_load_dwordx4 v[116:119], v13, s[16:19], s53 offen offset:1280 sc1
    s_mov_b64 exec, -1
    v_exp_f32 v163, v163
    v_exp_f32 v164, v164
    v_exp_f32 v165, v165
    v_exp_f32 v166, v166
    v_exp_f32 v167, v167
    v_smfmac_f32_32x32x32_bf16 v[32:47], v[80:83], v[158:165], v6
    v_exp_f32 v168, v168
    v_exp_f32 v169, v169
    v_exp_f32 v170, v170
    s_waitcnt vmcnt(9)
    v_mfma_f32_32x32x16_bf16 v[150:165], v[84:87], v[64:67], 0
    v_exp_f32 v171, v171
    v_exp_f32 v172, v172
    v_exp_f32 v173, v173
    v_exp_f32 v174, v174
    v_exp_f32 v175, v175
    v_smfmac_f32_32x32x32_bf16 v[48:63], v[76:79], v[166:173], v6
    v_exp_f32 v176, v176
    v_exp_f32 v177, v177
    v_exp_f32 v178, v178
    s_add_u32 m0, s45, 24576
    s_mov_b32 s49, 196608
    buffer_load_dwordx4 v5, s[20:23], s49 offen lds
    buffer_store_dwordx4 v[28:31], v1, s[16:19], s70 offen sc1
    s_cmp_lg_u32 s3, s5
    s_cbranch_scc1 L_noehc_r1
    s_lshl_b32 s49, s5, 5
    s_add_u32 s49, s49, s4
    s_lshl_b32 s49, s49, 9
    s_add_u32 s49, s49, 7208960
    s_mov_b64 exec, 1
    buffer_store_dword v28, v7, s[16:19], s49 offen sc1
    s_mov_b64 exec, -1
L_noehc_r1:
    v_exp_f32 v179, v179
    v_exp_f32 v180, v180
    v_exp_f32 v181, v181
    v_exp_f32 v150, v150
    v_exp_f32 v151, v151
    v_smfmac_f32_32x32x32_bf16 v[48:63], v[80:83], v[174:181], v6
    v_exp_f32 v152, v152
    v_exp_f32 v153, v153
    v_exp_f32 v154, v154
    v_mfma_f32_32x32x16_bf16 v[166:181], v[84:87], v[68:71], 0
    v_exp_f32 v155, v155
    v_exp_f32 v156, v156
    v_exp_f32 v157, v157
    v_exp_f32 v158, v158
    v_exp_f32 v159, v159
    v_smfmac_f32_32x32x32_bf16 v[32:47], v[88:91], v[150:157], v6
    v_exp_f32 v160, v160
    v_exp_f32 v161, v161
    v_exp_f32 v162, v162
    s_and_b32 s49, s78, 0xf0000
    s_cbranch_scc1 L_grp4_r1
L_grp4_r1_ret:
    s_add_u32 s53, s53, 0x10000
    s_and_b32 s53, s53, 0x7ffff
    buffer_load_dwordx4 v[120:123], v10, s[16:19], s53 offen sc1
    s_mov_b64 exec, s[56:57]
    buffer_load_dwordx4 v[124:127], v10, s[16:19], s53 offen offset:1024 sc1
    buffer_load_dwordx4 v[128:131], v10, s[16:19], s53 offen offset:1280 sc1
    s_mov_b64 exec, -1
    v_exp_f32 v163, v163
    v_exp_f32 v164, v164
    v_exp_f32 v165, v165
    v_exp_f32 v166, v166
    v_exp_f32 v167, v167
    v_smfmac_f32_32x32x32_bf16 v[32:47], v[92:95], v[158:165], v6
    v_exp_f32 v168, v168
    v_exp_f32 v169, v169
    v_exp_f32 v170, v170
    s_waitcnt vmcnt(9)
    v_mfma_f32_32x32x16_bf16 v[150:165], v[96:99], v[64:67], 0
    v_exp_f32 v171, v171
    v_exp_f32 v172, v172
    v_exp_f32 v173, v173
    v_exp_f32 v174, v174
    v_exp_f32 v175, v175
    v_smfmac_f32_32x32x32_bf16 v[48:63], v[88:91], v[166:173], v6
    v_exp_f32 v176, v176
    v_exp_f32 v177, v177
    v_exp_f32 v178, v178
    s_add_u32 m0, s45, 32768
    s_mov_b32 s49, 262144
    buffer_load_dwordx4 v5, s[20:23], s49 offen lds
    v_exp_f32 v179, v179
    v_exp_f32 v180, v180
    v_exp_f32 v181, v181
    s_mov_b64 exec, 1
    buffer_store_dword v8, v7, s[16:19], s62 offen
    buffer_store_dword v8, v7, s[16:19], s64 offen sc1
    s_mov_b64 exec, -1
    s_branch L_st1_ret
L_st3:
    s_cmp_ge_u32 s1, 28
    s_cbranch_scc1 L_st3_skip
    v_and_b32 v182, 60, v3
    s_lshl_b32 s62, s1, 7
    s_add_u32 s62, s62, 6303744
    buffer_load_dword v183, v182, s[16:19], s62 offen sc1
    v_exp_f32 v150, v150
    v_exp_f32 v151, v151
    v_smfmac_f32_32x32x32_bf16 v[48:63], v[128:131], v[174:181], v6
    v_exp_f32 v152, v152
    v_exp_f32 v153, v153
    v_exp_f32 v154, v154
    v_mfma_f32_32x32x16_bf16 v[166:181], v[132:135], v[68:71], 0
    v_exp_f32 v155, v155
    v_exp_f32 v156, v156
    v_exp_f32 v157, v157
    v_exp_f32 v158, v158
    v_exp_f32 v159, v159
    v_smfmac_f32_32x32x32_bf16 v[32:47], v[136:139], v[150:157], v6
    v_exp_f32 v160, v160
    v_exp_f32 v161, v161
    v_exp_f32 v162, v162
    s_and_b32 s49, s78, 0xf00000
    s_cbranch_scc1 L_grp5_r3
L_grp5_r3_ret:
    s_add_u32 s53, s53, 0x10000
    s_and_b32 s53, s53, 0x7ffff
    buffer_load_dwordx4 v[96:99], v10, s[16:19], s53 offen sc1
    s_mov_b64 exec, s[56:57]
    buffer_load_dwordx4 v[100:103], v10, s[16:19], s53 offen offset:1024 sc1
    buffer_load_dwordx4 v[104:107], v10, s[16:19], s53 offen offset:1280 sc1
    s_mov_b64 exec, -1
    v_exp_f32 v163, v163
    v_exp_f32 v164, v164
    v_exp_f32 v165, v165
    v_exp_f32 v166, v166
    v_exp_f32 v167, v167
    v_smfmac_f32_32x32x32_bf16 v[32:47], v[140:143], v[158:165], v6
    v_exp_f32 v168, v168
    v_exp_f32 v169, v169
    v_exp_f32 v170, v170
    s_waitcnt vmcnt(10)
    v_mfma_f32_32x32x16_bf16 v[150:165], v[72:75], v[64:67], 0
    v_exp_f32 v171, v171
    v_exp_f32 v172, v172
    v_exp_f32 v173, v173
    v_exp_f32 v174, v174
    v_exp_f32 v175, v175
    v_smfmac_f32_32x32x32_bf16 v[48:63], v[136:139], v[166:173], v6
    v_exp_f32 v176, v176
    v_exp_f32 v177, v177
    v_exp_f32 v178, v178
    s_add_u32 m0, s45, 65536
    s_mov_b32 s49, 128
    buffer_load_dwordx4 v5, s[20:23], s49 offen lds
    v_exp_f32 v179, v179
    v_exp_f32 v180, v180
    v_exp_f32 v181, v181
    s_waitcnt vmcnt(4)
    v_cmp_ne_u32 vcc, s44, v183
    s_nop 0
    s_cbranch_vccz L_gu_ok
    s_lshl_b32 s63, s1, 11
    s_add_u32 s63, s63, 6422528
    v_lshlrev_b32 v184, 5, v182
    s_mov_b32 s54, 24
    buffer_load_dword v183, v182, s[16:19], s62 offen sc1
L_guh:
    s_waitcnt vmcnt(0)
    v_cmp_ne_u32 vcc, s44, v183
    s_nop 0
    s_cbranch_vccz L_gudone
    buffer_load_dword v183, v182, s[16:19], s62 offen sc1
    s_sub_u32 s54, s54, 1
    s_cmp_lg_u32 s54, 0
    s_cbranch_scc1 L_guh
    s_mov_b32 s54, 65536
L_guf:
    buffer_load_dword v183, v184, s[16:19], s63 offen sc1
    s_waitcnt vmcnt(0) lgkmcnt(0)
    v_cmp_ne_u32 vcc, s44, v183
    s_nop 0
    s_cbranch_vccz L_guf_ok
    s_sub_u32 s54, s54, 1
    s_cmp_eq_u32 s54, 0
    s_cbranch_scc1 L_guf_ok
    s_sleep 4
    s_branch L_guf
L_guf_ok:
    s_nop 1
L_gudone:
L_gu_ok:
    s_lshl_b32 s62, s1, 13
    s_add_u32 s62, s62, 6815744
    s_add_u32 s63, s62, 4096
    buffer_load_dwordx4 v[200:203], v1, s[16:19], s62 offen offset:0 sc1
    buffer_load_dwordx4 v[204:207], v1, s[16:19], s62 offen offset:1024 sc1
    buffer_load_dwordx4 v[208:211], v1, s[16:19], s62 offen offset:2048 sc1
    buffer_load_dwordx4 v[212:215], v1, s[16:19], s62 offen offset:3072 sc1
    buffer_load_dwordx4 v[216:219], v1, s[16:19], s63 offen offset:0 sc1
    buffer_load_dwordx4 v[220:223], v1, s[16:19], s63 offen offset:1024 sc1
    buffer_load_dwordx4 v[224:227], v1, s[16:19], s63 offen offset:2048 sc1
    buffer_load_dwordx4 v[228:231], v1, s[16:19], s63 offen offset:3072 sc1
    v_and_b32 v190, 124, v3
    v_lshrrev_b32 v191, 5, v0
    v_lshl_add_u32 v190, v191, 1, v190
    v_add_u32 v190, 157952, v190
    v_exp_f32 v150, v150
    v_exp_f32 v151, v151
    v_smfmac_f32_32x32x32_bf16 v[48:63], v[140:143], v[174:181], v6
    v_exp_f32 v152, v152
    v_exp_f32 v153, v153
    v_exp_f32 v154, v154
    v_mfma_f32_32x32x16_bf16 v[166:181], v[72:75], v[68:71], 0
    v_exp_f32 v155, v155
    v_exp_f32 v156, v156
    v_exp_f32 v157, v157
    v_exp_f32 v158, v158
    v_exp_f32 v159, v159
    v_smfmac_f32_32x32x32_bf16 v[32:47], v[76:79], v[150:157], v6
    v_exp_f32 v160, v160
    v_exp_f32 v161, v161
    v_exp_f32 v162, v162
    buffer_load_dwordx4 v[108:111], v11, s[16:19], s53 offen sc1
    s_mov_b64 exec, s[56:57]
    buffer_load_dwordx4 v[112:115], v11, s[16:19], s53 offen offset:1024 sc1
    buffer_load_dwordx4 v[116:119], v11, s[16:19], s53 offen offset:1280 sc1
    s_mov_b64 exec, -1
    v_exp_f32 v163, v163
    v_exp_f32 v164, v164
    v_exp_f32 v165, v165
    v_exp_f32 v166, v166
    v_exp_f32 v167, v167
    v_smfmac_f32_32x32x32_bf16 v[32:47], v[80:83], v[158:165], v6
    v_exp_f32 v168, v168
    v_exp_f32 v169, v169
    v_exp_f32 v170, v170
    v_mfma_f32_32x32x16_bf16 v[150:165], v[84:87], v[64:67], 0
    v_exp_f32 v171, v171
    v_exp_f32 v172, v172
    v_exp_f32 v173, v173
    v_exp_f32 v174, v174
    v_exp_f32 v175, v175
    v_smfmac_f32_32x32x32_bf16 v[48:63], v[76:79], v[166:173], v6
    v_exp_f32 v176, v176
    v_exp_f32 v177, v177
    v_exp_f32 v178, v178
    s_add_u32 m0, s45, 73728
    s_mov_b32 s49, 65664
    buffer_load_dwordx4 v5, s[20:23], s49 offen lds
    v_exp_f32 v179, v179
    v_exp_f32 v180, v180
    v_exp_f32 v181, v181
    v_exp_f32 v150, v150
    v_exp_f32 v151, v151
    v_smfmac_f32_32x32x32_bf16 v[48:63], v[80:83], v[174:181], v6
    v_exp_f32 v152, v152
    v_exp_f32 v153, v153
    v_exp_f32 v154, v154
    v_mfma_f32_32x32x16_bf16 v[166:181], v[84:87], v[68:71], 0
    v_exp_f32 v155, v155
    v_exp_f32 v156, v156
    v_exp_f32 v157, v157
    v_exp_f32 v158, v158
    v_exp_f32 v159, v159
    v_smfmac_f32_32x32x32_bf16 v[32:47], v[88:91], v[150:157], v6
    v_exp_f32 v160, v160
    v_exp_f32 v161, v161
    v_exp_f32 v162, v162
    buffer_load_dwordx4 v[120:123], v12, s[16:19], s53 offen sc1
    s_mov_b64 exec, s[56:57]
    buffer_load_dwordx4 v[124:127], v12, s[16:19], s53 offen offset:1024 sc1
    buffer_load_dwordx4 v[128:131], v12, s[16:19], s53 offen offset:1280 sc1
    s_mov_b64 exec, -1
    v_exp_f32 v163, v163
    v_exp_f32 v164, v164
    v_exp_f32 v165, v165
    v_exp_f32 v166, v166
    v_exp_f32 v167, v167
    v_smfmac_f32_32x32x32_bf16 v[32:47], v[92:95], v[158:165], v6
    v_exp_f32 v168, v168
    v_exp_f32 v169, v169
    v_exp_f32 v170, v170
    s_waitcnt vmcnt(16)
    v_mfma_f32_32x32x16_bf16 v[150:165], v[96:99], v[64:67], 0
    v_exp_f32 v171, v171
    v_exp_f32 v172, v172
    v_exp_f32 v173, v173
    v_exp_f32 v174, v174
    v_exp_f32 v175, v175
    v_smfmac_f32_32x32x32_bf16 v[48:63], v[88:91], v[166:173], v6
    v_exp_f32 v176, v176
    v_exp_f32 v177, v177
    v_exp_f32 v178, v178
    s_add_u32 m0, s45, 81920
    s_mov_b32 s49, 131200
    buffer_load_dwordx4 v5, s[20:23], s49 offen lds
    v_exp_f32 v179, v179
    v_exp_f32 v180, v180
    v_exp_f32 v181, v181
    v_exp_f32 v150, v150
    v_exp_f32 v151, v151
    v_smfmac_f32_32x32x32_bf16 v[48:63], v[92:95], v[174:181], v6
    v_exp_f32 v152, v152
    v_exp_f32 v153, v153
    v_exp_f32 v154, v154
    v_mfma_f32_32x32x16_bf16 v[166:181], v[96:99], v[68:71], 0
    v_exp_f32 v155, v155
    v_exp_f32 v156, v156
    v_exp_f32 v157, v157
    v_exp_f32 v158, v158
    v_exp_f32 v159, v159
    v_smfmac_f32_32x32x32_bf16 v[32:47], v[100:103], v[150:157], v6
    v_exp_f32 v160, v160
    v_exp_f32 v161, v161
    v_exp_f32 v162, v162
    buffer_load_dwordx4 v[132:135], v13, s[16:19], s53 offen sc1
    s_mov_b64 exec, s[56:57]
    buffer_load_dwordx4 v[136:139], v13, s[16:19], s53 offen offset:1024 sc1
    buffer_load_dwordx4 v[140:143], v13, s[16:19], s53 offen offset:1280 sc1
    s_mov_b64 exec, -1
    v_exp_f32 v163, v163
    v_exp_f32 v164, v164
    v_exp_f32 v165, v165
    v_exp_f32 v166, v166
    v_exp_f32 v167, v167
    v_smfmac_f32_32x32x32_bf16 v[32:47], v[104:107], v[158:165], v6
    v_exp_f32 v168, v168
    v_exp_f32 v169, v169
    v_exp_f32 v170, v170
    s_waitcnt vmcnt(8)
    v_mfma_f32_32x32x16_bf16 v[150:165], v[108:111], v[64:67], 0
    v_exp_f32 v171, v171
    v_exp_f32 v172, v172
    v_exp_f32 v173, v173
    v_exp_f32 v174, v174
    v_exp_f32 v175, v175
    v_smfmac_f32_32x32x32_bf16 v[48:63], v[100:103], v[166:173], v6
    v_exp_f32 v176, v176
    v_exp_f32 v177, v177
    v_exp_f32 v178, v178
    s_add_u32 m0, s45, 90112
    s_mov_b32 s49, 196736
    buffer_load_dwordx4 v5, s[20:23], s49 offen lds
    v_exp_f32 v179, v179
    v_exp_f32 v180, v180
    v_exp_f32 v181, v181
    v_add_f32 v184, v200, v204
    v_add_f32 v185, v201, v205
    v_add_f32 v186, v202, v206
    v_add_f32 v187, v203, v207
    v_add_f32 v184, v184, v208
    v_add_f32 v185, v185, v209
    v_add_f32 v186, v186, v210
    v_add_f32 v187, v187, v211
    v_add_f32 v184, v184, v212
    v_add_f32 v185, v185, v213
    v_add_f32 v186, v186, v214
    v_add_f32 v187, v187, v215
    v_add_f32 v184, v184, v216
    v_add_f32 v185, v185, v217
    v_add_f32 v186, v186, v218
    v_add_f32 v187, v187, v219
    v_add_f32 v184, v184, v220
    v_add_f32 v185, v185, v221
    v_add_f32 v186, v186, v222
    v_add_f32 v187, v187, v223
    v_add_f32 v184, v184, v224
    v_add_f32 v185, v185, v225
    v_add_f32 v186, v186, v226
    v_add_f32 v187, v187, v227
    v_add_f32 v184, v184, v228
    v_add_f32 v185, v185, v229
    v_add_f32 v186, v186, v230
    v_add_f32 v187, v187, v231
    v_mov_b32 v188, 1
    v_mov_b32 v189, 157696
    v_permlane32_swap_b32 v184, v186
    v_permlane32_swap_b32 v185, v187
    v_cvt_pk_bf16_f32 v182, v184, v185
    v_cvt_pk_bf16_f32 v183, v186, v187
    v_lshlrev_b32 v184, 16, v182
    v_and_b32 v185, 0xffff0000, v182
    v_lshlrev_b32 v186, 16, v183
    v_and_b32 v187, 0xffff0000, v183
    v_mul_f32 v182, 0xbfb8aa3b, v184
    v_mul_f32 v183, 0xbfb8aa3b, v185
    v_exp_f32 v182, v182
    v_exp_f32 v183, v183
    v_add_f32 v182, 1.0, v182
    v_add_f32 v183, 1.0, v183
    v_rcp_f32 v182, v182
    v_rcp_f32 v183, v183
    v_mul_f32 v184, v184, v182
    v_mul_f32 v185, v185, v183
    v_cvt_pk_bf16_f32 v182, v184, v185
    v_lshlrev_b32 v184, 16, v182
    v_and_b32 v185, 0xffff0000, v182
    v_mul_f32 v184, v184, v186
    v_mul_f32 v185, v185, v187
    v_cvt_pk_bf16_f32 v182, v184, v185
    ds_write_b16 v190, v182
    ds_write_b16_d16_hi v190, v182 offset:128
    s_waitcnt lgkmcnt(0)
    ds_write_b32 v189, v188 offset:44
    s_branch L_st3_ret
L_st2:
    s_cmp_ge_u32 s1, 28
    s_cbranch_scc1 L_st2_skip
    s_lshl_b32 s80, s1, 16
    s_lshl_b32 s62, s0, 7
    s_add_u32 s80, s80, s62
    v_exp_f32 v150, v150
    v_exp_f32 v151, v151
    v_smfmac_f32_32x32x32_bf16 v[48:63], v[140:143], v[174:181], v6
    v_exp_f32 v152, v152
    v_exp_f32 v153, v153
    v_exp_f32 v154, v154
    v_mfma_f32_32x32x16_bf16 v[166:181], v[72:75], v[68:71], 0
    v_exp_f32 v155, v155
    v_exp_f32 v156, v156
    v_exp_f32 v157, v157
    v_exp_f32 v158, v158
    v_exp_f32 v159, v159
    v_smfmac_f32_32x32x32_bf16 v[32:47], v[76:79], v[150:157], v6
    v_exp_f32 v160, v160
    v_exp_f32 v161, v161
    v_exp_f32 v162, v162
    buffer_load_dwordx4 v[108:111], v13, s[16:19], s53 offen sc1
    s_mov_b64 exec, s[56:57]
    buffer_load_dwordx4 v[112:115], v13, s[16:19], s53 offen offset:1024 sc1
    buffer_load_dwordx4 v[116:119], v13, s[16:19], s53 offen offset:1280 sc1
    s_mov_b64 exec, -1
    v_exp_f32 v163, v163
    v_exp_f32 v164, v164
    v_exp_f32 v165, v165
    v_exp_f32 v166, v166
    v_exp_f32 v167, v167
    v_smfmac_f32_32x32x32_bf16 v[32:47], v[80:83], v[158:165], v6
    v_exp_f32 v168, v168
    v_exp_f32 v169, v169
    v_exp_f32 v170, v170
    s_waitcnt vmcnt(8)
    v_mfma_f32_32x32x16_bf16 v[150:165], v[84:87], v[64:67], 0
    v_exp_f32 v171, v171
    v_exp_f32 v172, v172
    v_exp_f32 v173, v173
    v_exp_f32 v174, v174
    v_exp_f32 v175, v175
    v_smfmac_f32_32x32x32_bf16 v[48:63], v[76:79], v[166:173], v6
    v_exp_f32 v176, v176
    v_exp_f32 v177, v177
    v_exp_f32 v178, v178
    s_add_u32 m0, s45, 24576
    s_mov_b32 s49, 196608
    buffer_load_dwordx4 v5, s[20:23], s49 offen lds
    s_add_u32 m0, s81, 0
    s_add_u32 s49, s80, 0
    buffer_load_dwordx4 v23, s[36:39], s49 offen nt lds
    s_add_u32 m0, s81, 1024
    s_add_u32 s49, s80, 8192
    buffer_load_dwordx4 v24, s[36:39], s49 offen nt lds
    buffer_store_dwordx4 v[28:31], v1, s[16:19], s70 offen sc1
    s_cmp_lg_u32 s3, s5
    s_cbranch_scc1 L_noehc_r2
    s_lshl_b32 s49, s5, 5
    s_add_u32 s49, s49, s4
    s_lshl_b32 s49, s49, 9
    s_add_u32 s49, s49, 7208960
    s_mov_b64 exec, 1
    buffer_store_dword v28, v7, s[16:19], s49 offen sc1
    s_mov_b64 exec, -1
L_noehc_r2:
    v_exp_f32 v179, v179
    v_exp_f32 v180, v180
    v_exp_f32 v181, v181
    v_exp_f32 v150, v150
    v_exp_f32 v151, v151
    v_smfmac_f32_32x32x32_bf16 v[48:63], v[80:83], v[174:181], v6
    v_exp_f32 v152, v152
    v_exp_f32 v153, v153
    v_exp_f32 v154, v154
    v_mfma_f32_32x32x16_bf16 v[166:181], v[84:87], v[68:71], 0
    v_exp_f32 v155, v155
    v_exp_f32 v156, v156
    v_exp_f32 v157, v157
    v_exp_f32 v158, v158
    v_exp_f32 v159, v159
    v_smfmac_f32_32x32x32_bf16 v[32:47], v[88:91], v[150:157], v6
    v_exp_f32 v160, v160
    v_exp_f32 v161, v161
    v_exp_f32 v162, v162
    s_and_b32 s49, s78, 0xf0000
    s_cbranch_scc1 L_grp4_r2
L_grp4_r2_ret:
    s_add_u32 s53, s53, 0x10000
    s_and_b32 s53, s53, 0x7ffff
    buffer_load_dwordx4 v[120:123], v10, s[16:19], s53 offen sc1
    s_mov_b64 exec, s[56:57]
    buffer_load_dwordx4 v[124:127], v10, s[16:19], s53 offen offset:1024 sc1
    buffer_load_dwordx4 v[128:131], v10, s[16:19], s53 offen offset:1280 sc1
    s_mov_b64 exec, -1
    v_exp_f32 v163, v163
    v_exp_f32 v164, v164
    v_exp_f32 v165, v165
    v_exp_f32 v166, v166
    v_exp_f32 v167, v167
    v_smfmac_f32_32x32x32_bf16 v[32:47], v[92:95], v[158:165], v6
    v_exp_f32 v168, v168
    v_exp_f32 v169, v169
    v_exp_f32 v170, v170
    s_waitcnt vmcnt(11)
    v_mfma_f32_32x32x16_bf16 v[150:165], v[96:99], v[64:67], 0
    v_exp_f32 v171, v171
    v_exp_f32 v172, v172
    v_exp_f32 v173, v173
    v_exp_f32 v174, v174
    v_exp_f32 v175, v175
    v_smfmac_f32_32x32x32_bf16 v[48:63], v[88:91], v[166:173], v6
    v_exp_f32 v176, v176
    v_exp_f32 v177, v177
    v_exp_f32 v178, v178
    s_add_u32 m0, s45, 32768
    s_mov_b32 s49, 262144
    buffer_load_dwordx4 v5, s[20:23], s49 offen lds
    s_add_u32 m0, s81, 2048
    s_add_u32 s49, s80, 16384
    buffer_load_dwordx4 v23, s[36:39], s49 offen nt lds
    s_add_u32 m0, s81, 3072
    s_add_u32 s49, s80, 24576
    buffer_load_dwordx4 v24, s[36:39], s49 offen nt lds
    v_exp_f32 v179, v179
    v_exp_f32 v180, v180
    v_exp_f32 v181, v181
    v_exp_f32 v150, v150
    v_exp_f32 v151, v151
    v_smfmac_f32_32x32x32_bf16 v[48:63], v[92:95], v[174:181], v6
    v_exp_f32 v152, v152
    v_exp_f32 v153, v153
    v_exp_f32 v154, v154
    v_mfma_f32_32x32x16_bf16 v[166:181], v[96:99], v[68:71], 0
    v_exp_f32 v155, v155
    v_exp_f32 v156, v156
    v_exp_f32 v157, v157
    v_exp_f32 v158, v158
    v_exp_f32 v159, v159
    v_smfmac_f32_32x32x32_bf16 v[32:47], v[100:103], v[150:157], v6
    v_exp_f32 v160, v160
    v_exp_f32 v161, v161
    v_exp_f32 v162, v162
    buffer_load_dwordx4 v[132:135], v11, s[16:19], s53 offen sc1
    s_mov_b64 exec, s[56:57]
    buffer_load_dwordx4 v[136:139], v11, s[16:19], s53 offen offset:1024 sc1
    buffer_load_dwordx4 v[140:143], v11, s[16:19], s53 offen offset:1280 sc1
    s_mov_b64 exec, -1
    v_exp_f32 v163, v163
    v_exp_f32 v164, v164
    v_exp_f32 v165, v165
    v_exp_f32 v166, v166
    v_exp_f32 v167, v167
    v_smfmac_f32_32x32x32_bf16 v[32:47], v[104:107], v[158:165], v6
    v_exp_f32 v168, v168
    v_exp_f32 v169, v169
    v_exp_f32 v170, v170
    s_waitcnt vmcnt(13)
    v_mfma_f32_32x32x16_bf16 v[150:165], v[108:111], v[64:67], 0
    v_exp_f32 v171, v171
    v_exp_f32 v172, v172
    v_exp_f32 v173, v173
    v_exp_f32 v174, v174
    v_exp_f32 v175, v175
    v_smfmac_f32_32x32x32_bf16 v[48:63], v[100:103], v[166:173], v6
    v_exp_f32 v176, v176
    v_exp_f32 v177, v177
    v_exp_f32 v178, v178
    s_add_u32 m0, s45, 40960
    s_mov_b32 s49, 327680
    buffer_load_dwordx4 v5, s[20:23], s49 offen lds
    s_add_u32 m0, s81, 4096
    s_add_u32 s49, s80, 32768
    buffer_load_dwordx4 v23, s[36:39], s49 offen nt lds
    s_add_u32 m0, s81, 5120
    s_add_u32 s49, s80, 40960
    buffer_load_dwordx4 v24, s[36:39], s49 offen nt lds
    v_exp_f32 v179, v179
    v_exp_f32 v180, v180
    v_exp_f32 v181, v181
    v_exp_f32 v150, v150
    v_exp_f32 v151, v151
    v_smfmac_f32_32x32x32_bf16 v[48:63], v[104:107], v[174:181], v6
    v_exp_f32 v152, v152
    v_exp_f32 v153, v153
    v_exp_f32 v154, v154
    v_mfma_f32_32x32x16_bf16 v[166:181], v[108:111], v[68:71], 0
    v_exp_f32 v155, v155
    v_exp_f32 v156, v156
    v_exp_f32 v157, v157
    v_exp_f32 v158, v158
    v_exp_f32 v159, v159
    v_smfmac_f32_32x32x32_bf16 v[32:47], v[112:115], v[150:157], v6
    v_exp_f32 v160, v160
    v_exp_f32 v161, v161
    v_exp_f32 v162, v162
    buffer_load_dwordx4 v[72:75], v12, s[16:19], s53 offen sc1
    s_mov_b64 exec, s[56:57]
    buffer_load_dwordx4 v[76:79], v12, s[16:19], s53 offen offset:1024 sc1
    buffer_load_dwordx4 v[80:83], v12, s[16:19], s53 offen offset:1280 sc1
    s_mov_b64 exec, -1
    v_exp_f32 v163, v163
    v_exp_f32 v164, v164
    v_exp_f32 v165, v165
    v_exp_f32 v166, v166
    v_exp_f32 v167, v167
    v_smfmac_f32_32x32x32_bf16 v[32:47], v[116:119], v[158:165], v6
    v_exp_f32 v168, v168
    v_exp_f32 v169, v169
    v_exp_f32 v170, v170
    s_waitcnt vmcnt(12)
    v_mfma_f32_32x32x16_bf16 v[150:165], v[120:123], v[64:67], 0
    v_exp_f32 v171, v171
    v_exp_f32 v172, v172
    v_exp_f32 v173, v173
    v_exp_f32 v174, v174
    v_exp_f32 v175, v175
    v_smfmac_f32_32x32x32_bf16 v[48:63], v[112:115], v[166:173], v6
    v_exp_f32 v176, v176
    v_exp_f32 v177, v177
    v_exp_f32 v178, v178
    s_add_u32 m0, s45, 49152
    s_mov_b32 s49, 393216
    buffer_load_dwordx4 v5, s[20:23], s49 offen lds
    s_add_u32 m0, s81, 6144
    s_add_u32 s49, s80, 49152
    buffer_load_dwordx4 v23, s[36:39], s49 offen nt lds
    s_add_u32 m0, s81, 7168
    s_add_u32 s49, s80, 57344
    buffer_load_dwordx4 v24, s[36:39], s49 offen nt lds
    s_mov_b64 exec, 1
    buffer_store_dword v8, v7, s[16:19], s71 offen sc1
    s_mov_b64 exec, -1
    v_exp_f32 v179, v179
    v_exp_f32 v180, v180
    v_exp_f32 v181, v181
    v_exp_f32 v150, v150
    v_exp_f32 v151, v151
    v_smfmac_f32_32x32x32_bf16 v[48:63], v[116:119], v[174:181], v6
    v_exp_f32 v152, v152
    v_exp_f32 v153, v153
    v_exp_f32 v154, v154
    v_mfma_f32_32x32x16_bf16 v[166:181], v[120:123], v[68:71], 0
    v_exp_f32 v155, v155
    v_exp_f32 v156, v156
    v_exp_f32 v157, v157
    v_exp_f32 v158, v158
    v_exp_f32 v159, v159
    v_smfmac_f32_32x32x32_bf16 v[32:47], v[124:127], v[150:157], v6
    v_exp_f32 v160, v160
    v_exp_f32 v161, v161
    v_exp_f32 v162, v162
    buffer_load_dwordx4 v[84:87], v13, s[16:19], s53 offen sc1
    s_mov_b64 exec, s[56:57]
    buffer_load_dwordx4 v[88:91], v13, s[16:19], s53 offen offset:1024 sc1
    buffer_load_dwordx4 v[92:95], v13, s[16:19], s53 offen offset:1280 sc1
    s_mov_b64 exec, -1
    v_exp_f32 v163, v163
    v_exp_f32 v164, v164
    v_exp_f32 v165, v165
    v_exp_f32 v166, v166
    v_exp_f32 v167, v167
    v_smfmac_f32_32x32x32_bf16 v[32:47], v[128:131], v[158:165], v6
    v_exp_f32 v168, v168
    v_exp_f32 v169, v169
    v_exp_f32 v170, v170
    s_waitcnt vmcnt(13)
    v_mfma_f32_32x32x16_bf16 v[150:165], v[132:135], v[64:67], 0
    v_exp_f32 v171, v171
    v_exp_f32 v172, v172
    v_exp_f32 v173, v173
    v_exp_f32 v174, v174
    v_exp_f32 v175, v175
    v_smfmac_f32_32x32x32_bf16 v[48:63], v[124:127], v[166:173], v6
    v_exp_f32 v176, v176
    v_exp_f32 v177, v177
    v_exp_f32 v178, v178
    s_add_u32 m0, s45, 57344
    s_mov_b32 s49, 458752
    buffer_load_dwordx4 v5, s[20:23], s49 offen lds
    v_exp_f32 v179, v179
    v_exp_f32 v180, v180
    v_exp_f32 v181, v181
    v_exp_f32 v150, v150
    v_exp_f32 v151, v151
    v_smfmac_f32_32x32x32_bf16 v[48:63], v[128:131], v[174:181], v6
    v_exp_f32 v152, v152
    v_exp_f32 v153, v153
    v_exp_f32 v154, v154
    v_mfma_f32_32x32x16_bf16 v[166:181], v[132:135], v[68:71], 0
    v_exp_f32 v155, v155
    v_exp_f32 v156, v156
    v_exp_f32 v157, v157
    v_exp_f32 v158, v158
    v_exp_f32 v159, v159
    v_smfmac_f32_32x32x32_bf16 v[32:47], v[136:139], v[150:157], v6
    v_exp_f32 v160, v160
    v_exp_f32 v161, v161
    v_exp_f32 v162, v162
    s_and_b32 s49, s78, 0xf00000
    s_cbranch_scc1 L_grp5_r2
L_grp5_r2_ret:
    s_add_u32 s53, s53, 0x10000
    s_and_b32 s53, s53, 0x7ffff
    buffer_load_dwordx4 v[96:99], v10, s[16:19], s53 offen sc1
    s_mov_b64 exec, s[56:57]
    buffer_load_dwordx4 v[100:103], v10, s[16:19], s53 offen offset:1024 sc1
    buffer_load_dwordx4 v[104:107], v10, s[16:19], s53 offen offset:1280 sc1
    s_mov_b64 exec, -1
    v_exp_f32 v163, v163
    v_exp_f32 v164, v164
    v_exp_f32 v165, v165
    v_exp_f32 v166, v166
    v_exp_f32 v167, v167
    v_smfmac_f32_32x32x32_bf16 v[32:47], v[140:143], v[158:165], v6
    v_exp_f32 v168, v168
    v_exp_f32 v169, v169
    v_exp_f32 v170, v170
    s_waitcnt vmcnt(11)
    v_mfma_f32_32x32x16_bf16 v[150:165], v[72:75], v[64:67], 0
    v_exp_f32 v171, v171
    v_exp_f32 v172, v172
    v_exp_f32 v173, v173
    v_exp_f32 v174, v174
    v_exp_f32 v175, v175
    v_smfmac_f32_32x32x32_bf16 v[48:63], v[136:139], v[166:173], v6
    v_exp_f32 v176, v176
    v_exp_f32 v177, v177
    v_exp_f32 v178, v178
    s_add_u32 m0, s45, 65536
    s_mov_b32 s49, 128
    buffer_load_dwordx4 v5, s[20:23], s49 offen lds
    v_exp_f32 v179, v179
    v_exp_f32 v180, v180
    v_exp_f32 v181, v181
    v_exp_f32 v150, v150
    v_exp_f32 v151, v151
    v_smfmac_f32_32x32x32_bf16 v[48:63], v[140:143], v[174:181], v6
    v_exp_f32 v152, v152
    v_exp_f32 v153, v153
    v_exp_f32 v154, v154
    v_mfma_f32_32x32x16_bf16 v[166:181], v[72:75], v[68:71], 0
    v_exp_f32 v155, v155
    v_exp_f32 v156, v156
    v_exp_f32 v157, v157
    v_exp_f32 v158, v158
    v_exp_f32 v159, v159
    v_smfmac_f32_32x32x32_bf16 v[32:47], v[76:79], v[150:157], v6
    v_exp_f32 v160, v160
    v_exp_f32 v161, v161
    v_exp_f32 v162, v162
    buffer_load_dwordx4 v[108:111], v11, s[16:19], s53 offen sc1
    s_mov_b64 exec, s[56:57]
    buffer_load_dwordx4 v[112:115], v11, s[16:19], s53 offen offset:1024 sc1
    buffer_load_dwordx4 v[116:119], v11, s[16:19], s53 offen offset:1280 sc1
    s_mov_b64 exec, -1
    v_exp_f32 v163, v163
    v_exp_f32 v164, v164
    v_exp_f32 v165, v165
    v_exp_f32 v166, v166
    v_exp_f32 v167, v167
    v_smfmac_f32_32x32x32_bf16 v[32:47], v[80:83], v[158:165], v6
    v_exp_f32 v168, v168
    v_exp_f32 v169, v169
    v_exp_f32 v170, v170
    s_waitcnt vmcnt(8)
    v_mfma_f32_32x32x16_bf16 v[150:165], v[84:87], v[64:67], 0
    v_exp_f32 v171, v171
    v_exp_f32 v172, v172
    v_exp_f32 v173, v173
    v_exp_f32 v174, v174
    v_exp_f32 v175, v175
    v_smfmac_f32_32x32x32_bf16 v[48:63], v[76:79], v[166:173], v6
    v_exp_f32 v176, v176
    v_exp_f32 v177, v177
    v_exp_f32 v178, v178
    s_add_u32 m0, s45, 73728
    s_mov_b32 s49, 65664
    buffer_load_dwordx4 v5, s[20:23], s49 offen lds
    v_exp_f32 v179, v179
    v_exp_f32 v180, v180
    v_exp_f32 v181, v181
    v_exp_f32 v150, v150
    v_exp_f32 v151, v151
    v_smfmac_f32_32x32x32_bf16 v[48:63], v[80:83], v[174:181], v6
    v_exp_f32 v152, v152
    v_exp_f32 v153, v153
    v_exp_f32 v154, v154
    v_mfma_f32_32x32x16_bf16 v[166:181], v[84:87], v[68:71], 0
    v_exp_f32 v155, v155
    v_exp_f32 v156, v156
    v_exp_f32 v157, v157
    v_exp_f32 v158, v158
    v_exp_f32 v159, v159
    v_smfmac_f32_32x32x32_bf16 v[32:47], v[88:91], v[150:157], v6
    v_exp_f32 v160, v160
    v_exp_f32 v161, v161
    v_exp_f32 v162, v162
    buffer_load_dwordx4 v[120:123], v12, s[16:19], s53 offen sc1
    s_mov_b64 exec, s[56:57]
    buffer_load_dwordx4 v[124:127], v12, s[16:19], s53 offen offset:1024 sc1
    buffer_load_dwordx4 v[128:131], v12, s[16:19], s53 offen offset:1280 sc1
    s_mov_b64 exec, -1
    v_exp_f32 v163, v163
    v_exp_f32 v164, v164
    v_exp_f32 v165, v165
    v_exp_f32 v166, v166
    v_exp_f32 v167, v167
    v_smfmac_f32_32x32x32_bf16 v[32:47], v[92:95], v[158:165], v6
    v_exp_f32 v168, v168
    v_exp_f32 v169, v169
    v_exp_f32 v170, v170
    s_waitcnt vmcnt(8)
    v_mfma_f32_32x32x16_bf16 v[150:165], v[96:99], v[64:67], 0
    v_exp_f32 v171, v171
    v_exp_f32 v172, v172
    v_exp_f32 v173, v173
    v_exp_f32 v174, v174
    v_exp_f32 v175, v175
    v_smfmac_f32_32x32x32_bf16 v[48:63], v[88:91], v[166:173], v6
    v_exp_f32 v176, v176
    v_exp_f32 v177, v177
    v_exp_f32 v178, v178
    s_add_u32 m0, s45, 81920
    s_mov_b32 s49, 131200
    buffer_load_dwordx4 v5, s[20:23], s49 offen lds
    v_exp_f32 v179, v179
    v_exp_f32 v180, v180
    v_exp_f32 v181, v181
    v_exp_f32 v150, v150
    v_exp_f32 v151, v151
    v_smfmac_f32_32x32x32_bf16 v[48:63], v[92:95], v[174:181], v6
    v_exp_f32 v152, v152
    v_exp_f32 v153, v153
    v_exp_f32 v154, v154
    v_mfma_f32_32x32x16_bf16 v[166:181], v[96:99], v[68:71], 0
    v_exp_f32 v155, v155
    v_exp_f32 v156, v156
    v_exp_f32 v157, v157
    v_exp_f32 v158, v158
    v_exp_f32 v159, v159
    v_smfmac_f32_32x32x32_bf16 v[32:47], v[100:103], v[150:157], v6
    v_exp_f32 v160, v160
    v_exp_f32 v161, v161
    v_exp_f32 v162, v162
    buffer_load_dwordx4 v[132:135], v13, s[16:19], s53 offen sc1
    s_mov_b64 exec, s[56:57]
    buffer_load_dwordx4 v[136:139], v13, s[16:19], s53 offen offset:1024 sc1
    buffer_load_dwordx4 v[140:143], v13, s[16:19], s53 offen offset:1280 sc1
    s_mov_b64 exec, -1
    v_exp_f32 v163, v163
    v_exp_f32 v164, v164
    v_exp_f32 v165, v165
    v_exp_f32 v166, v166
    v_exp_f32 v167, v167
    v_smfmac_f32_32x32x32_bf16 v[32:47], v[104:107], v[158:165], v6
    v_exp_f32 v168, v168
    v_exp_f32 v169, v169
    v_exp_f32 v170, v170
    s_waitcnt vmcnt(8)
    v_mfma_f32_32x32x16_bf16 v[150:165], v[108:111], v[64:67], 0
    v_exp_f32 v171, v171
    v_exp_f32 v172, v172
    v_exp_f32 v173, v173
    v_exp_f32 v174, v174
    v_exp_f32 v175, v175
    v_smfmac_f32_32x32x32_bf16 v[48:63], v[100:103], v[166:173], v6
    v_exp_f32 v176, v176
    v_exp_f32 v177, v177
    v_exp_f32 v178, v178
    s_add_u32 m0, s45, 90112
    s_mov_b32 s49, 196736
    buffer_load_dwordx4 v5, s[20:23], s49 offen lds
    v_exp_f32 v179, v179
    v_exp_f32 v180, v180
    v_exp_f32 v181, v181
    v_exp_f32 v150, v150
    v_exp_f32 v151, v151
    v_smfmac_f32_32x32x32_bf16 v[48:63], v[104:107], v[174:181], v6
    v_exp_f32 v152, v152
    v_exp_f32 v153, v153
    v_exp_f32 v154, v154
    v_mfma_f32_32x32x16_bf16 v[166:181], v[108:111], v[68:71], 0
    v_exp_f32 v155, v155
    v_exp_f32 v156, v156
    v_exp_f32 v157, v157
    v_exp_f32 v158, v158
    v_exp_f32 v159, v159
    v_smfmac_f32_32x32x32_bf16 v[32:47], v[112:115], v[150:157], v6
    v_exp_f32 v160, v160
    v_exp_f32 v161, v161
    v_exp_f32 v162, v162
    s_and_b32 s49, s78, 0xf000000
    s_cbranch_scc1 L_grp6_r2
L_grp6_r2_ret:
    s_add_u32 s53, s53, 0x10000
    s_and_b32 s53, s53, 0x7ffff
    buffer_load_dwordx4 v[72:75], v10, s[16:19], s53 offen sc1
    s_mov_b64 exec, s[56:57]
    buffer_load_dwordx4 v[76:79], v10, s[16:19], s53 offen offset:1024 sc1
    buffer_load_dwordx4 v[80:83], v10, s[16:19], s53 offen offset:1280 sc1
    s_mov_b64 exec, -1
    v_exp_f32 v163, v163
    v_exp_f32 v164, v164
    v_exp_f32 v165, v165
    v_exp_f32 v166, v166
    v_exp_f32 v167, v167
    v_smfmac_f32_32x32x32_bf16 v[32:47], v[116:119], v[158:165], v6
    v_exp_f32 v168, v168
    v_exp_f32 v169, v169
    v_exp_f32 v170, v170
    s_waitcnt vmcnt(8)
    v_mfma_f32_32x32x16_bf16 v[150:165], v[120:123], v[64:67], 0
    v_exp_f32 v171, v171
    v_exp_f32 v172, v172
    v_exp_f32 v173, v173
    v_exp_f32 v174, v174
    v_exp_f32 v175, v175
    v_smfmac_f32_32x32x32_bf16 v[48:63], v[112:115], v[166:173], v6
    v_exp_f32 v176, v176
    v_exp_f32 v177, v177
    v_exp_f32 v178, v178
    s_add_u32 m0, s45, 98304
    s_mov_b32 s49, 262272
    buffer_load_dwordx4 v5, s[20:23], s49 offen lds
    v_exp_f32 v179, v179
    v_exp_f32 v180, v180
    v_exp_f32 v181, v181
    ds_read_b64_tr_b16 v[200:201], v252 offset:0
    ds_read_b64_tr_b16 v[202:203], v252 offset:512
    ds_read_b64_tr_b16 v[204:205], v252 offset:4096
    ds_read_b64_tr_b16 v[206:207], v252 offset:4608
    ds_read_b64_tr_b16 v[208:209], v253 offset:0
    ds_read_b64_tr_b16 v[210:211], v253 offset:512
    ds_read_b64_tr_b16 v[212:213], v253 offset:4096
    ds_read_b64_tr_b16 v[214:215], v253 offset:4608
    ds_read_b64_tr_b16 v[216:217], v254 offset:0
    ds_read_b64_tr_b16 v[218:219], v254 offset:512
    ds_read_b64_tr_b16 v[220:221], v254 offset:4096
    ds_read_b64_tr_b16 v[222:223], v254 offset:4608
    ds_read_b64_tr_b16 v[224:225], v255 offset:0
    ds_read_b64_tr_b16 v[226:227], v255 offset:512
    ds_read_b64_tr_b16 v[228:229], v255 offset:4096
    ds_read_b64_tr_b16 v[230:231], v255 offset:4608
    v_and_b32 v191, 1, v0
    v_and_b32 v190, 48, v0
    v_lshl_add_u32 v191, v191, 7, v190
    v_add_u32 v191, 157952, v191
    v_mov_b32 v189, 157696
    s_mov_b32 s54, 65536
L_hpoll:
    ds_read_b32 v188, v189 offset:44
    s_waitcnt lgkmcnt(0)
    v_cmp_eq_u32 vcc, 0, v188
    s_nop 0
    s_cbranch_vccz L_hpoll_ok
    s_sub_u32 s54, s54, 1
    s_cmp_eq_u32 s54, 0
    s_cbranch_scc1 L_hpoll_ok
    s_sleep 2
    s_branch L_hpoll
L_hpoll_ok:
    s_nop 1
    ds_read_b128 v[192:195], v191
    ds_read_b128 v[196:199], v191 offset:64
    s_lshl_b32 s63, s1, 12
    s_lshl_b32 s62, s0, 9
    s_add_u32 s63, s63, s62
    s_add_u32 s63, s63, 7077888
    s_lshl_b32 s62, s0, 5
    s_add_u32 s62, s62, s1
    s_mul_i32 s62, s62, 32
    s_add_u32 s62, s62, 6316032
    v_lshlrev_b32 v182, 3, v0
    s_waitcnt lgkmcnt(0)
    v_mfma_f32_16x16x32_bf16 v[232:235], v[192:195], v[200:203], 0
    v_mfma_f32_16x16x32_bf16 v[236:239], v[192:195], v[208:211], 0
    v_mfma_f32_16x16x32_bf16 v[240:243], v[192:195], v[216:219], 0
    v_mfma_f32_16x16x32_bf16 v[244:247], v[192:195], v[224:227], 0
    v_mfma_f32_16x16x32_bf16 v[232:235], v[196:199], v[204:207], v[232:235]
    v_mfma_f32_16x16x32_bf16 v[236:239], v[196:199], v[212:215], v[236:239]
    v_mfma_f32_16x16x32_bf16 v[240:243], v[196:199], v[220:223], v[240:243]
    v_mfma_f32_16x16x32_bf16 v[244:247], v[196:199], v[228:231], v[244:247]
    s_lshl_b64 exec, exec, 16
    s_nop 4
    v_mov_b32 v232, v236
    v_mov_b32 v233, v237
    s_lshl_b64 exec, exec, 16
    v_mov_b32 v232, v240
    v_mov_b32 v233, v241
    s_lshl_b64 exec, exec, 16
    v_mov_b32 v232, v244
    v_mov_b32 v233, v245
    s_mov_b64 exec, -1
    buffer_store_dwordx2 v[232:233], v182, s[16:19], s63 offen sc1
    v_exp_f32 v150, v150
    v_exp_f32 v151, v151
    v_smfmac_f32_32x32x32_bf16 v[48:63], v[116:119], v[174:181], v6
    v_exp_f32 v152, v152
    v_exp_f32 v153, v153
    v_exp_f32 v154, v154
    v_mfma_f32_32x32x16_bf16 v[166:181], v[120:123], v[68:71], 0
    v_exp_f32 v155, v155
    v_exp_f32 v156, v156
    v_exp_f32 v157, v157
    v_exp_f32 v158, v158
    v_exp_f32 v159, v159
    v_smfmac_f32_32x32x32_bf16 v[32:47], v[124:127], v[150:157], v6
    v_exp_f32 v160, v160
    v_exp_f32 v161, v161
    v_exp_f32 v162, v162
    buffer_load_dwordx4 v[84:87], v11, s[16:19], s53 offen sc1
    s_mov_b64 exec, s[56:57]
    buffer_load_dwordx4 v[88:91], v11, s[16:19], s53 offen offset:1024 sc1
    buffer_load_dwordx4 v[92:95], v11, s[16:19], s53 offen offset:1280 sc1
    s_mov_b64 exec, -1
    v_exp_f32 v163, v163
    v_exp_f32 v164, v164
    v_exp_f32 v165, v165
    v_exp_f32 v166, v166
    v_exp_f32 v167, v167
    v_smfmac_f32_32x32x32_bf16 v[32:47], v[128:131], v[158:165], v6
    v_exp_f32 v168, v168
    v_exp_f32 v169, v169
    v_exp_f32 v170, v170
    s_waitcnt vmcnt(9)
    v_mfma_f32_32x32x16_bf16 v[150:165], v[132:135], v[64:67], 0
    v_exp_f32 v171, v171
    v_exp_f32 v172, v172
    v_exp_f32 v173, v173
    v_exp_f32 v174, v174
    v_exp_f32 v175, v175
    v_smfmac_f32_32x32x32_bf16 v[48:63], v[124:127], v[166:173], v6
    v_exp_f32 v176, v176
    v_exp_f32 v177, v177
    v_exp_f32 v178, v178
    s_add_u32 m0, s45, 106496
    s_mov_b32 s49, 327808
    buffer_load_dwordx4 v5, s[20:23], s49 offen lds
    v_exp_f32 v179, v179
    v_exp_f32 v180, v180
    v_exp_f32 v181, v181
    v_exp_f32 v150, v150
    v_exp_f32 v151, v151
    v_smfmac_f32_32x32x32_bf16 v[48:63], v[128:131], v[174:181], v6
    v_exp_f32 v152, v152
    v_exp_f32 v153, v153
    v_exp_f32 v154, v154
    v_mfma_f32_32x32x16_bf16 v[166:181], v[132:135], v[68:71], 0
    v_exp_f32 v155, v155
    v_exp_f32 v156, v156
    v_exp_f32 v157, v157
    v_exp_f32 v158, v158
    v_exp_f32 v159, v159
    v_smfmac_f32_32x32x32_bf16 v[32:47], v[136:139], v[150:157], v6
    v_exp_f32 v160, v160
    v_exp_f32 v161, v161
    v_exp_f32 v162, v162
    buffer_load_dwordx4 v[96:99], v12, s[16:19], s53 offen sc1
    s_mov_b64 exec, s[56:57]
    buffer_load_dwordx4 v[100:103], v12, s[16:19], s53 offen offset:1024 sc1
    buffer_load_dwordx4 v[104:107], v12, s[16:19], s53 offen offset:1280 sc1
    s_mov_b64 exec, -1
    v_exp_f32 v163, v163
    v_exp_f32 v164, v164
    v_exp_f32 v165, v165
    v_exp_f32 v166, v166
    v_exp_f32 v167, v167
    v_smfmac_f32_32x32x32_bf16 v[32:47], v[140:143], v[158:165], v6
    v_exp_f32 v168, v168
    v_exp_f32 v169, v169
    v_exp_f32 v170, v170
    s_waitcnt vmcnt(9)
    v_mfma_f32_32x32x16_bf16 v[150:165], v[72:75], v[64:67], 0
    v_exp_f32 v171, v171
    v_exp_f32 v172, v172
    v_exp_f32 v173, v173
    v_exp_f32 v174, v174
    v_exp_f32 v175, v175
    v_smfmac_f32_32x32x32_bf16 v[48:63], v[136:139], v[166:173], v6
    v_exp_f32 v176, v176
    v_exp_f32 v177, v177
    v_exp_f32 v178, v178
    s_add_u32 m0, s45, 114688
    s_mov_b32 s49, 393344
    buffer_load_dwordx4 v5, s[20:23], s49 offen lds
    v_exp_f32 v179, v179
    v_exp_f32 v180, v180
    v_exp_f32 v181, v181
    v_exp_f32 v150, v150
    v_exp_f32 v151, v151
    v_smfmac_f32_32x32x32_bf16 v[48:63], v[140:143], v[174:181], v6
    v_exp_f32 v152, v152
    v_exp_f32 v153, v153
    v_exp_f32 v154, v154
    v_mfma_f32_32x32x16_bf16 v[166:181], v[72:75], v[68:71], 0
    v_exp_f32 v155, v155
    v_exp_f32 v156, v156
    v_exp_f32 v157, v157
    v_exp_f32 v158, v158
    v_exp_f32 v159, v159
    v_smfmac_f32_32x32x32_bf16 v[32:47], v[76:79], v[150:157], v6
    v_exp_f32 v160, v160
    v_exp_f32 v161, v161
    v_exp_f32 v162, v162
    buffer_load_dwordx4 v[108:111], v13, s[16:19], s53 offen sc1
    s_mov_b64 exec, s[56:57]
    buffer_load_dwordx4 v[112:115], v13, s[16:19], s53 offen offset:1024 sc1
    buffer_load_dwordx4 v[116:119], v13, s[16:19], s53 offen offset:1280 sc1
    s_mov_b64 exec, -1
    v_exp_f32 v163, v163
    v_exp_f32 v164, v164
    v_exp_f32 v165, v165
    v_exp_f32 v166, v166
    v_exp_f32 v167, v167
    v_smfmac_f32_32x32x32_bf16 v[32:47], v[80:83], v[158:165], v6
    v_exp_f32 v168, v168
    v_exp_f32 v169, v169
    v_exp_f32 v170, v170
    s_waitcnt vmcnt(8)
    v_mfma_f32_32x32x16_bf16 v[150:165], v[84:87], v[64:67], 0
    v_exp_f32 v171, v171
    v_exp_f32 v172, v172
    v_exp_f32 v173, v173
    v_exp_f32 v174, v174
    v_exp_f32 v175, v175
    v_smfmac_f32_32x32x32_bf16 v[48:63], v[76:79], v[166:173], v6
    v_exp_f32 v176, v176
    v_exp_f32 v177, v177
    v_exp_f32 v178, v178
    s_add_u32 m0, s45, 122880
    s_mov_b32 s49, 458880
    buffer_load_dwordx4 v5, s[20:23], s49 offen lds
    v_exp_f32 v179, v179
    v_exp_f32 v180, v180
    v_exp_f32 v181, v181
    s_mov_b64 exec, 1
    buffer_store_dword v8, v7, s[16:19], s62 offen sc1
    s_mov_b64 exec, -1
    s_branch L_st2_ret
L_y1:
    v_min_u32 v184, 864, v9
    s_and_b32 s62, s4, 3
    s_lshl_b32 s62, s62, 1
    s_add_u32 s62, s62, s7
    s_mul_i32 s62, s62, 1024
    s_add_u32 s62, s62, 6316032
    buffer_load_dword v145, v184, s[16:19], s62 offen sc1
    ds_read_b64 v[186:187], v26 offset:16
    s_branch L_y1_ret
L_y2:
    s_waitcnt vmcnt(0)
    v_cmp_ne_u32 vcc, s44, v145
    s_nop 0
    s_cbranch_vccz L_yf_done
    s_mov_b32 s54, 65536
L_yfpoll:
    buffer_load_dword v145, v184, s[16:19], s62 offen sc1
    s_waitcnt vmcnt(0)
    v_cmp_ne_u32 vcc, s44, v145
    s_nop 0
    s_cbranch_vccz L_yfpoll_ok
    s_sub_u32 s54, s54, 1
    s_cmp_eq_u32 s54, 0
    s_cbranch_scc1 L_yfpoll_ok
    s_sleep 4
    s_branch L_yfpoll
L_yfpoll_ok:
    s_nop 1
L_yf_done:
    s_and_b32 s62, s4, 3
    s_lshl_b32 s62, s62, 3
    s_add_u32 s62, s62, s3
    s_lshl_b32 s62, s62, 7
    s_add_u32 s62, s62, 7077888
    v_and_b32 v184, 15, v0
    v_and_b32 v185, 48, v0
    v_lshlrev_b32 v185, 8, v185
    v_lshl_add_u32 v185, v184, 3, v185
    buffer_load_dwordx2 v[116:117], v185, s[16:19], s62 offen sc1
    s_add_u32 s62, s62, 16384
    buffer_load_dwordx2 v[118:119], v185, s[16:19], s62 offen sc1
    s_add_u32 s62, s62, 16384
    buffer_load_dwordx2 v[120:121], v185, s[16:19], s62 offen sc1
    s_add_u32 s62, s62, 16384
    buffer_load_dwordx2 v[122:123], v185, s[16:19], s62 offen sc1
    s_add_u32 s62, s62, 16384
    buffer_load_dwordx2 v[124:125], v185, s[16:19], s62 offen sc1
    s_add_u32 s62, s62, 16384
    buffer_load_dwordx2 v[126:127], v185, s[16:19], s62 offen sc1
    s_add_u32 s62, s62, 16384
    buffer_load_dwordx2 v[128:129], v185, s[16:19], s62 offen sc1
    s_add_u32 s62, s62, 16384
    s_branch L_y2_ret
L_y3:
    s_mov_b32 vcc_lo, 0
    s_mov_b32 vcc_hi, -1
    v_cndmask_b32 v186, v186, v187, vcc
    v_ashrrev_i32 v187, 31, v186
    v_not_b32 v187, v187
    v_or_b32 v187, 0x80000000, v187
    v_xor_b32 v186, v186, v187
    v_and_b32 v186, 0xffff0000, v186
    v_mul_f32 v186, 0xbfb8aa3b, v186
    v_exp_f32 v186, v186
    s_nop 0
    v_add_f32 v186, 1.0, v186
    v_rcp_f32 v186, v186
    s_nop 0
    v_cvt_pk_bf16_f32 v186, v186, v186
    v_lshlrev_b32 v186, 16, v186
    v_and_b32 v188, 15, v0
    v_and_b32 v189, 32, v0
    v_lshl_add_u32 v188, v189, 2, v188
    v_lshl_add_u32 v188, s3, 4, v188
    v_lshlrev_b32 v188, 2, v188
    v_add_u32 v188, 158720, v188
    s_waitcnt vmcnt(5)
    v_pk_add_f32 v[116:117], v[116:117], v[118:119]
    v_pk_add_f32 v[116:117], v[116:117], v[120:121]
    v_pk_add_f32 v[116:117], v[116:117], v[122:123]
    v_pk_add_f32 v[116:117], v[116:117], v[124:125]
    v_pk_add_f32 v[116:117], v[116:117], v[126:127]
    v_pk_add_f32 v[116:117], v[116:117], v[128:129]
    s_nop 1
    v_permlane32_swap_b32 v116, v117
    v_add_f32 v116, v116, v117
    v_mov_b32 v117, v116
    s_nop 1
    v_permlane16_swap_b32 v116, v117
    v_add_f32 v116, v116, v117
    v_cvt_pk_bf16_f32 v116, v116, v116
    v_lshlrev_b32 v116, 16, v116
    v_mul_f32 v116, v116, v186
    v_cvt_pk_bf16_f32 v116, v116, v116
    v_lshlrev_b32 v116, 16, v116
    ds_write_b32 v188, v116
    s_branch L_y3_ret
L_grp1:
    s_mov_b32 s54, 24
    buffer_load_dword v145, v149, s[16:19], s76 offen sc1
L_grp1h:
    s_waitcnt vmcnt(0)
    v_cmp_ne_u32 vcc, s44, v145
    s_and_b32 s50, s4, 28
    s_lshr_b64 vcc, vcc, s50
    s_mov_b32 s78, vcc_lo
    s_and_b32 vcc_lo, vcc_lo, 0xf0
    s_mov_b32 vcc_hi, 0
    s_mov_b64 vcc, vcc
    s_cbranch_vccz L_grp1done
    buffer_load_dword v145, v149, s[16:19], s76 offen sc1
    s_sub_u32 s54, s54, 1
    s_cmp_lg_u32 s54, 0
    s_cbranch_scc1 L_grp1h
    s_mov_b32 s54, 65536
L_grp1f:
    buffer_load_dword v145, v148, s[16:19], s74 offen sc1
    s_waitcnt vmcnt(0) lgkmcnt(0)
    v_cmp_ne_u32 vcc, s44, v145
    s_and_b32 s50, s4, 28
    s_lshr_b64 vcc, vcc, s50
    s_mov_b32 s78, vcc_lo
    s_and_b32 vcc_lo, vcc_lo, 0xf0
    s_mov_b32 vcc_hi, 0
    s_mov_b64 vcc, vcc
    s_cbranch_vccz L_grp1f_ok
    s_sub_u32 s54, s54, 1
    s_cmp_eq_u32 s54, 0
    s_cbranch_scc1 L_grp1f_ok
    s_sleep 4
    s_branch L_grp1f
L_grp1f_ok:
    s_nop 1
L_grp1done:
    s_branch L_grp1_ret
L_grp2:
    s_mov_b32 s54, 24
    buffer_load_dword v145, v149, s[16:19], s76 offen sc1
L_grp2h:
    s_waitcnt vmcnt(0)
    v_cmp_ne_u32 vcc, s44, v145
    s_and_b32 s50, s4, 28
    s_lshr_b64 vcc, vcc, s50
    s_mov_b32 s78, vcc_lo
    s_and_b32 vcc_lo, vcc_lo, 0xf00
    s_mov_b32 vcc_hi, 0
    s_mov_b64 vcc, vcc
    s_cbranch_vccz L_grp2done
    buffer_load_dword v145, v149, s[16:19], s76 offen sc1
    s_sub_u32 s54, s54, 1
    s_cmp_lg_u32 s54, 0
    s_cbranch_scc1 L_grp2h
    s_mov_b32 s54, 65536
L_grp2f:
    buffer_load_dword v145, v148, s[16:19], s74 offen sc1
    s_waitcnt vmcnt(0) lgkmcnt(0)
    v_cmp_ne_u32 vcc, s44, v145
    s_and_b32 s50, s4, 28
    s_lshr_b64 vcc, vcc, s50
    s_mov_b32 s78, vcc_lo
    s_and_b32 vcc_lo, vcc_lo, 0xf00
    s_mov_b32 vcc_hi, 0
    s_mov_b64 vcc, vcc
    s_cbranch_vccz L_grp2f_ok
    s_sub_u32 s54, s54, 1
    s_cmp_eq_u32 s54, 0
    s_cbranch_scc1 L_grp2f_ok
    s_sleep 4
    s_branch L_grp2f
L_grp2f_ok:
    s_nop 1
L_grp2done:
    s_branch L_grp2_ret
L_grp3:
    s_mov_b32 s54, 24
    buffer_load_dword v145, v149, s[16:19], s76 offen sc1
L_grp3h:
    s_waitcnt vmcnt(0)
    v_cmp_ne_u32 vcc, s44, v145
    s_and_b32 s50, s4, 28
    s_lshr_b64 vcc, vcc, s50
    s_mov_b32 s78, vcc_lo
    s_and_b32 vcc_lo, vcc_lo, 0xf000
    s_mov_b32 vcc_hi, 0
    s_mov_b64 vcc, vcc
    s_cbranch_vccz L_grp3done
    buffer_load_dword v145, v149, s[16:19], s76 offen sc1
    s_sub_u32 s54, s54, 1
    s_cmp_lg_u32 s54, 0
    s_cbranch_scc1 L_grp3h
    s_mov_b32 s54, 65536
L_grp3f:
    buffer_load_dword v145, v148, s[16:19], s74 offen sc1
    s_waitcnt vmcnt(0) lgkmcnt(0)
    v_cmp_ne_u32 vcc, s44, v145
    s_and_b32 s50, s4, 28
    s_lshr_b64 vcc, vcc, s50
    s_mov_b32 s78, vcc_lo
    s_and_b32 vcc_lo, vcc_lo, 0xf000
    s_mov_b32 vcc_hi, 0
    s_mov_b64 vcc, vcc
    s_cbranch_vccz L_grp3f_ok
    s_sub_u32 s54, s54, 1
    s_cmp_eq_u32 s54, 0
    s_cbranch_scc1 L_grp3f_ok
    s_sleep 4
    s_branch L_grp3f
L_grp3f_ok:
    s_nop 1
L_grp3done:
    s_branch L_grp3_ret
L_grp4:
    s_mov_b32 s54, 24
    buffer_load_dword v145, v149, s[16:19], s76 offen sc1
L_grp4h:
    s_waitcnt vmcnt(0)
    v_cmp_ne_u32 vcc, s44, v145
    s_and_b32 s50, s4, 28
    s_lshr_b64 vcc, vcc, s50
    s_mov_b32 s78, vcc_lo
    s_and_b32 vcc_lo, vcc_lo, 0xf0000
    s_mov_b32 vcc_hi, 0
    s_mov_b64 vcc, vcc
    s_cbranch_vccz L_grp4done
    buffer_load_dword v145, v149, s[16:19], s76 offen sc1
    s_sub_u32 s54, s54, 1
    s_cmp_lg_u32 s54, 0
    s_cbranch_scc1 L_grp4h
    s_mov_b32 s54, 65536
L_grp4f:
    buffer_load_dword v145, v148, s[16:19], s74 offen sc1
    s_waitcnt vmcnt(0) lgkmcnt(0)
    v_cmp_ne_u32 vcc, s44, v145
    s_and_b32 s50, s4, 28
    s_lshr_b64 vcc, vcc, s50
    s_mov_b32 s78, vcc_lo
    s_and_b32 vcc_lo, vcc_lo, 0xf0000
    s_mov_b32 vcc_hi, 0
    s_mov_b64 vcc, vcc
    s_cbranch_vccz L_grp4f_ok
    s_sub_u32 s54, s54, 1
    s_cmp_eq_u32 s54, 0
    s_cbranch_scc1 L_grp4f_ok
    s_sleep 4
    s_branch L_grp4f
L_grp4f_ok:
    s_nop 1
L_grp4done:
    s_branch L_grp4_ret
L_grp5:
    s_mov_b32 s54, 24
    buffer_load_dword v145, v149, s[16:19], s76 offen sc1
L_grp5h:
    s_waitcnt vmcnt(0)
    v_cmp_ne_u32 vcc, s44, v145
    s_and_b32 s50, s4, 28
    s_lshr_b64 vcc, vcc, s50
    s_mov_b32 s78, vcc_lo
    s_and_b32 vcc_lo, vcc_lo, 0xf00000
    s_mov_b32 vcc_hi, 0
    s_mov_b64 vcc, vcc
    s_cbranch_vccz L_grp5done
    buffer_load_dword v145, v149, s[16:19], s76 offen sc1
    s_sub_u32 s54, s54, 1
    s_cmp_lg_u32 s54, 0
    s_cbranch_scc1 L_grp5h
    s_mov_b32 s54, 65536
L_grp5f:
    buffer_load_dword v145, v148, s[16:19], s74 offen sc1
    s_waitcnt vmcnt(0) lgkmcnt(0)
    v_cmp_ne_u32 vcc, s44, v145
    s_and_b32 s50, s4, 28
    s_lshr_b64 vcc, vcc, s50
    s_mov_b32 s78, vcc_lo
    s_and_b32 vcc_lo, vcc_lo, 0xf00000
    s_mov_b32 vcc_hi, 0
    s_mov_b64 vcc, vcc
    s_cbranch_vccz L_grp5f_ok
    s_sub_u32 s54, s54, 1
    s_cmp_eq_u32 s54, 0
    s_cbranch_scc1 L_grp5f_ok
    s_sleep 4
    s_branch L_grp5f
L_grp5f_ok:
    s_nop 1
L_grp5done:
    s_branch L_grp5_ret
L_grp6:
    s_mov_b32 s54, 24
    buffer_load_dword v145, v149, s[16:19], s76 offen sc1
L_grp6h:
    s_waitcnt vmcnt(0)
    v_cmp_ne_u32 vcc, s44, v145
    s_and_b32 s50, s4, 28
    s_lshr_b64 vcc, vcc, s50
    s_mov_b32 s78, vcc_lo
    s_and_b32 vcc_lo, vcc_lo, 0xf000000
    s_mov_b32 vcc_hi, 0
    s_mov_b64 vcc, vcc
    s_cbranch_vccz L_grp6done
    buffer_load_dword v145, v149, s[16:19], s76 offen sc1
    s_sub_u32 s54, s54, 1
    s_cmp_lg_u32 s54, 0
    s_cbranch_scc1 L_grp6h
    s_mov_b32 s54, 65536
L_grp6f:
    buffer_load_dword v145, v148, s[16:19], s74 offen sc1
    s_waitcnt vmcnt(0) lgkmcnt(0)
    v_cmp_ne_u32 vcc, s44, v145
    s_and_b32 s50, s4, 28
    s_lshr_b64 vcc, vcc, s50
    s_mov_b32 s78, vcc_lo
    s_and_b32 vcc_lo, vcc_lo, 0xf000000
    s_mov_b32 vcc_hi, 0
    s_mov_b64 vcc, vcc
    s_cbranch_vccz L_grp6f_ok
    s_sub_u32 s54, s54, 1
    s_cmp_eq_u32 s54, 0
    s_cbranch_scc1 L_grp6f_ok
    s_sleep 4
    s_branch L_grp6f
L_grp6f_ok:
    s_nop 1
L_grp6done:
    s_branch L_grp6_ret
L_grp7:
    s_mov_b32 s54, 24
    buffer_load_dword v145, v149, s[16:19], s76 offen sc1
L_grp7h:
    s_waitcnt vmcnt(0)
    v_cmp_ne_u32 vcc, s44, v145
    s_and_b32 s50, s4, 28
    s_lshr_b64 vcc, vcc, s50
    s_mov_b32 s78, vcc_lo
    s_and_b32 vcc_lo, vcc_lo, 0xf0000000
    s_mov_b32 vcc_hi, 0
    s_mov_b64 vcc, vcc
    s_cbranch_vccz L_grp7done
    buffer_load_dword v145, v149, s[16:19], s76 offen sc1
    s_sub_u32 s54, s54, 1
    s_cmp_lg_u32 s54, 0
    s_cbranch_scc1 L_grp7h
    s_mov_b32 s54, 65536
L_grp7f:
    buffer_load_dword v145, v148, s[16:19], s74 offen sc1
    s_waitcnt vmcnt(0) lgkmcnt(0)
    v_cmp_ne_u32 vcc, s44, v145
    s_and_b32 s50, s4, 28
    s_lshr_b64 vcc, vcc, s50
    s_mov_b32 s78, vcc_lo
    s_and_b32 vcc_lo, vcc_lo, 0xf0000000
    s_mov_b32 vcc_hi, 0
    s_mov_b64 vcc, vcc
    s_cbranch_vccz L_grp7f_ok
    s_sub_u32 s54, s54, 1
    s_cmp_eq_u32 s54, 0
    s_cbranch_scc1 L_grp7f_ok
    s_sleep 4
    s_branch L_grp7f
L_grp7f_ok:
    s_nop 1
L_grp7done:
    s_branch L_grp7_ret
L_grp2_r0:
    s_mov_b32 s54, 24
    buffer_load_dword v145, v149, s[16:19], s76 offen sc1
L_grp2_r0h:
    s_waitcnt vmcnt(0)
    v_cmp_ne_u32 vcc, s44, v145
    s_and_b32 s50, s4, 28
    s_lshr_b64 vcc, vcc, s50
    s_mov_b32 s78, vcc_lo
    s_and_b32 vcc_lo, vcc_lo, 0xf00
    s_mov_b32 vcc_hi, 0
    s_mov_b64 vcc, vcc
    s_cbranch_vccz L_grp2_r0done
    buffer_load_dword v145, v149, s[16:19], s76 offen sc1
    s_sub_u32 s54, s54, 1
    s_cmp_lg_u32 s54, 0
    s_cbranch_scc1 L_grp2_r0h
    s_mov_b32 s54, 65536
L_grp2_r0f:
    buffer_load_dword v145, v148, s[16:19], s74 offen sc1
    s_waitcnt vmcnt(0) lgkmcnt(0)
    v_cmp_ne_u32 vcc, s44, v145
    s_and_b32 s50, s4, 28
    s_lshr_b64 vcc, vcc, s50
    s_mov_b32 s78, vcc_lo
    s_and_b32 vcc_lo, vcc_lo, 0xf00
    s_mov_b32 vcc_hi, 0
    s_mov_b64 vcc, vcc
    s_cbranch_vccz L_grp2_r0f_ok
    s_sub_u32 s54, s54, 1
    s_cmp_eq_u32 s54, 0
    s_cbranch_scc1 L_grp2_r0f_ok
    s_sleep 4
    s_branch L_grp2_r0f
L_grp2_r0f_ok:
    s_nop 1
L_grp2_r0done:
    s_branch L_grp2_r0_ret
L_grp2_r1:
    s_mov_b32 s54, 24
    buffer_load_dword v145, v149, s[16:19], s76 offen sc1
L_grp2_r1h:
    s_waitcnt vmcnt(0)
    v_cmp_ne_u32 vcc, s44, v145
    s_and_b32 s50, s4, 28
    s_lshr_b64 vcc, vcc, s50
    s_mov_b32 s78, vcc_lo
    s_and_b32 vcc_lo, vcc_lo, 0xf00
    s_mov_b32 vcc_hi, 0
    s_mov_b64 vcc, vcc
    s_cbranch_vccz L_grp2_r1done
    buffer_load_dword v145, v149, s[16:19], s76 offen sc1
    s_sub_u32 s54, s54, 1
    s_cmp_lg_u32 s54, 0
    s_cbranch_scc1 L_grp2_r1h
    s_mov_b32 s54, 65536
L_grp2_r1f:
    buffer_load_dword v145, v148, s[16:19], s74 offen sc1
    s_waitcnt vmcnt(0) lgkmcnt(0)
    v_cmp_ne_u32 vcc, s44, v145
    s_and_b32 s50, s4, 28
    s_lshr_b64 vcc, vcc, s50
    s_mov_b32 s78, vcc_lo
    s_and_b32 vcc_lo, vcc_lo, 0xf00
    s_mov_b32 vcc_hi, 0
    s_mov_b64 vcc, vcc
    s_cbranch_vccz L_grp2_r1f_ok
    s_sub_u32 s54, s54, 1
    s_cmp_eq_u32 s54, 0
    s_cbranch_scc1 L_grp2_r1f_ok
    s_sleep 4
    s_branch L_grp2_r1f
L_grp2_r1f_ok:
    s_nop 1
L_grp2_r1done:
    s_branch L_grp2_r1_ret
L_grp3_r1:
    s_mov_b32 s54, 24
    buffer_load_dword v145, v149, s[16:19], s76 offen sc1
L_grp3_r1h:
    s_waitcnt vmcnt(0)
    v_cmp_ne_u32 vcc, s44, v145
    s_and_b32 s50, s4, 28
    s_lshr_b64 vcc, vcc, s50
    s_mov_b32 s78, vcc_lo
    s_and_b32 vcc_lo, vcc_lo, 0xf000
    s_mov_b32 vcc_hi, 0
    s_mov_b64 vcc, vcc
    s_cbranch_vccz L_grp3_r1done
    buffer_load_dword v145, v149, s[16:19], s76 offen sc1
    s_sub_u32 s54, s54, 1
    s_cmp_lg_u32 s54, 0
    s_cbranch_scc1 L_grp3_r1h
    s_mov_b32 s54, 65536
L_grp3_r1f:
    buffer_load_dword v145, v148, s[16:19], s74 offen sc1
    s_waitcnt vmcnt(0) lgkmcnt(0)
    v_cmp_ne_u32 vcc, s44, v145
    s_and_b32 s50, s4, 28
    s_lshr_b64 vcc, vcc, s50
    s_mov_b32 s78, vcc_lo
    s_and_b32 vcc_lo, vcc_lo, 0xf000
    s_mov_b32 vcc_hi, 0
    s_mov_b64 vcc, vcc
    s_cbranch_vccz L_grp3_r1f_ok
    s_sub_u32 s54, s54, 1
    s_cmp_eq_u32 s54, 0
    s_cbranch_scc1 L_grp3_r1f_ok
    s_sleep 4
    s_branch L_grp3_r1f
L_grp3_r1f_ok:
    s_nop 1
L_grp3_r1done:
    s_branch L_grp3_r1_ret
L_grp4_r1:
    s_mov_b32 s54, 24
    buffer_load_dword v145, v149, s[16:19], s76 offen sc1
L_grp4_r1h:
    s_waitcnt vmcnt(0)
    v_cmp_ne_u32 vcc, s44, v145
    s_and_b32 s50, s4, 28
    s_lshr_b64 vcc, vcc, s50
    s_mov_b32 s78, vcc_lo
    s_and_b32 vcc_lo, vcc_lo, 0xf0000
    s_mov_b32 vcc_hi, 0
    s_mov_b64 vcc, vcc
    s_cbranch_vccz L_grp4_r1done
    buffer_load_dword v145, v149, s[16:19], s76 offen sc1
    s_sub_u32 s54, s54, 1
    s_cmp_lg_u32 s54, 0
    s_cbranch_scc1 L_grp4_r1h
    s_mov_b32 s54, 65536
L_grp4_r1f:
    buffer_load_dword v145, v148, s[16:19], s74 offen sc1
    s_waitcnt vmcnt(0) lgkmcnt(0)
    v_cmp_ne_u32 vcc, s44, v145
    s_and_b32 s50, s4, 28
    s_lshr_b64 vcc, vcc, s50
    s_mov_b32 s78, vcc_lo
    s_and_b32 vcc_lo, vcc_lo, 0xf0000
    s_mov_b32 vcc_hi, 0
    s_mov_b64 vcc, vcc
    s_cbranch_vccz L_grp4_r1f_ok
    s_sub_u32 s54, s54, 1
    s_cmp_eq_u32 s54, 0
    s_cbranch_scc1 L_grp4_r1f_ok
    s_sleep 4
    s_branch L_grp4_r1f
L_grp4_r1f_ok:
    s_nop 1
L_grp4_r1done:
    s_branch L_grp4_r1_ret
L_grp5_r3:
    s_mov_b32 s54, 24
    buffer_load_dword v145, v149, s[16:19], s76 offen sc1
L_grp5_r3h:
    s_waitcnt vmcnt(0)
    v_cmp_ne_u32 vcc, s44, v145
    s_and_b32 s50, s4, 28
    s_lshr_b64 vcc, vcc, s50
    s_mov_b32 s78, vcc_lo
    s_and_b32 vcc_lo, vcc_lo, 0xf00000
    s_mov_b32 vcc_hi, 0
    s_mov_b64 vcc, vcc
    s_cbranch_vccz L_grp5_r3done
    buffer_load_dword v145, v149, s[16:19], s76 offen sc1
    s_sub_u32 s54, s54, 1
    s_cmp_lg_u32 s54, 0
    s_cbranch_scc1 L_grp5_r3h
    s_mov_b32 s54, 65536
L_grp5_r3f:
    buffer_load_dword v145, v148, s[16:19], s74 offen sc1
    s_waitcnt vmcnt(0) lgkmcnt(0)
    v_cmp_ne_u32 vcc, s44, v145
    s_and_b32 s50, s4, 28
    s_lshr_b64 vcc, vcc, s50
    s_mov_b32 s78, vcc_lo
    s_and_b32 vcc_lo, vcc_lo, 0xf00000
    s_mov_b32 vcc_hi, 0
    s_mov_b64 vcc, vcc
    s_cbranch_vccz L_grp5_r3f_ok
    s_sub_u32 s54, s54, 1
    s_cmp_eq_u32 s54, 0
    s_cbranch_scc1 L_grp5_r3f_ok
    s_sleep 4
    s_branch L_grp5_r3f
L_grp5_r3f_ok:
    s_nop 1
L_grp5_r3done:
    s_branch L_grp5_r3_ret
L_grp4_r2:
    s_mov_b32 s54, 24
    buffer_load_dword v145, v149, s[16:19], s76 offen sc1
L_grp4_r2h:
    s_waitcnt vmcnt(0)
    v_cmp_ne_u32 vcc, s44, v145
    s_and_b32 s50, s4, 28
    s_lshr_b64 vcc, vcc, s50
    s_mov_b32 s78, vcc_lo
    s_and_b32 vcc_lo, vcc_lo, 0xf0000
    s_mov_b32 vcc_hi, 0
    s_mov_b64 vcc, vcc
    s_cbranch_vccz L_grp4_r2done
    buffer_load_dword v145, v149, s[16:19], s76 offen sc1
    s_sub_u32 s54, s54, 1
    s_cmp_lg_u32 s54, 0
    s_cbranch_scc1 L_grp4_r2h
    s_mov_b32 s54, 65536
L_grp4_r2f:
    buffer_load_dword v145, v148, s[16:19], s74 offen sc1
    s_waitcnt vmcnt(0) lgkmcnt(0)
    v_cmp_ne_u32 vcc, s44, v145
    s_and_b32 s50, s4, 28
    s_lshr_b64 vcc, vcc, s50
    s_mov_b32 s78, vcc_lo
    s_and_b32 vcc_lo, vcc_lo, 0xf0000
    s_mov_b32 vcc_hi, 0
    s_mov_b64 vcc, vcc
    s_cbranch_vccz L_grp4_r2f_ok
    s_sub_u32 s54, s54, 1
    s_cmp_eq_u32 s54, 0
    s_cbranch_scc1 L_grp4_r2f_ok
    s_sleep 4
    s_branch L_grp4_r2f
L_grp4_r2f_ok:
    s_nop 1
L_grp4_r2done:
    s_branch L_grp4_r2_ret
L_grp5_r2:
    s_mov_b32 s54, 24
    buffer_load_dword v145, v149, s[16:19], s76 offen sc1
L_grp5_r2h:
    s_waitcnt vmcnt(0)
    v_cmp_ne_u32 vcc, s44, v145
    s_and_b32 s50, s4, 28
    s_lshr_b64 vcc, vcc, s50
    s_mov_b32 s78, vcc_lo
    s_and_b32 vcc_lo, vcc_lo, 0xf00000
    s_mov_b32 vcc_hi, 0
    s_mov_b64 vcc, vcc
    s_cbranch_vccz L_grp5_r2done
    buffer_load_dword v145, v149, s[16:19], s76 offen sc1
    s_sub_u32 s54, s54, 1
    s_cmp_lg_u32 s54, 0
    s_cbranch_scc1 L_grp5_r2h
    s_mov_b32 s54, 65536
L_grp5_r2f:
    buffer_load_dword v145, v148, s[16:19], s74 offen sc1
    s_waitcnt vmcnt(0) lgkmcnt(0)
    v_cmp_ne_u32 vcc, s44, v145
    s_and_b32 s50, s4, 28
    s_lshr_b64 vcc, vcc, s50
    s_mov_b32 s78, vcc_lo
    s_and_b32 vcc_lo, vcc_lo, 0xf00000
    s_mov_b32 vcc_hi, 0
    s_mov_b64 vcc, vcc
    s_cbranch_vccz L_grp5_r2f_ok
    s_sub_u32 s54, s54, 1
    s_cmp_eq_u32 s54, 0
    s_cbranch_scc1 L_grp5_r2f_ok
    s_sleep 4
    s_branch L_grp5_r2f
L_grp5_r2f_ok:
    s_nop 1
L_grp5_r2done:
    s_branch L_grp5_r2_ret
L_grp6_r2:
    s_mov_b32 s54, 24
    buffer_load_dword v145, v149, s[16:19], s76 offen sc1
L_grp6_r2h:
    s_waitcnt vmcnt(0)
    v_cmp_ne_u32 vcc, s44, v145
    s_and_b32 s50, s4, 28
    s_lshr_b64 vcc, vcc, s50
    s_mov_b32 s78, vcc_lo
    s_and_b32 vcc_lo, vcc_lo, 0xf000000
    s_mov_b32 vcc_hi, 0
    s_mov_b64 vcc, vcc
    s_cbranch_vccz L_grp6_r2done
    buffer_load_dword v145, v149, s[16:19], s76 offen sc1
    s_sub_u32 s54, s54, 1
    s_cmp_lg_u32 s54, 0
    s_cbranch_scc1 L_grp6_r2h
    s_mov_b32 s54, 65536
L_grp6_r2f:
    buffer_load_dword v145, v148, s[16:19], s74 offen sc1
    s_waitcnt vmcnt(0) lgkmcnt(0)
    v_cmp_ne_u32 vcc, s44, v145
    s_and_b32 s50, s4, 28
    s_lshr_b64 vcc, vcc, s50
    s_mov_b32 s78, vcc_lo
    s_and_b32 vcc_lo, vcc_lo, 0xf000000
    s_mov_b32 vcc_hi, 0
    s_mov_b64 vcc, vcc
    s_cbranch_vccz L_grp6_r2f_ok
    s_sub_u32 s54, s54, 1
    s_cmp_eq_u32 s54, 0
    s_cbranch_scc1 L_grp6_r2f_ok
    s_sleep 4
    s_branch L_grp6_r2f
L_grp6_r2f_ok:
    s_nop 1
L_grp6_r2done:
    s_branch L_grp6_r2_ret
L_fallback:
    s_nop 7
    s_lshl_b32 s49, s5, 19
    s_lshl_b32 s50, s6, 11
    s_add_u32 s49, s49, s50
    v_add_u32 v182, s49, v1
    v_mov_b32 v183, 0xff800000
    s_mov_b32 s51, 0
L_fb1:
    s_lshl_b32 s49, s51, 13
    buffer_load_dwordx4 v[72:75], v182, s[16:19], s49 offen sc1
    s_waitcnt vmcnt(0)
    v_mfma_f32_32x32x16_bf16 v[150:165], v[72:75], v[68:71], 0
    s_nop 11
    v_max3_f32 v183, v150, v151, v183
    v_max3_f32 v183, v152, v153, v183
    v_max3_f32 v183, v154, v155, v183
    v_max3_f32 v183, v156, v157, v183
    v_max3_f32 v183, v158, v159, v183
    v_max3_f32 v183, v160, v161, v183
    v_max3_f32 v183, v162, v163, v183
    v_max3_f32 v183, v164, v165, v183
    s_add_u32 s51, s51, 1
    s_cmp_lt_u32 s51, 64
    s_cbranch_scc1 L_fb1
    v_mov_b32 v184, v183
    s_nop 1
    v_permlane32_swap_b32 v183, v184
    v_max_f32 v183, v183, v184
    v_sub_f32 v166, 0, v183
    v_mov_b32 v48, 0
    v_sub_f32 v167, 0, v183
    v_mov_b32 v49, 0
    v_sub_f32 v168, 0, v183
    v_mov_b32 v50, 0
    v_sub_f32 v169, 0, v183
    v_mov_b32 v51, 0
    v_sub_f32 v170, 0, v183
    v_mov_b32 v52, 0
    v_sub_f32 v171, 0, v183
    v_mov_b32 v53, 0
    v_sub_f32 v172, 0, v183
    v_mov_b32 v54, 0
    v_sub_f32 v173, 0, v183
    v_mov_b32 v55, 0
    v_sub_f32 v174, 0, v183
    v_mov_b32 v56, 0
    v_sub_f32 v175, 0, v183
    v_mov_b32 v57, 0
    v_sub_f32 v176, 0, v183
    v_mov_b32 v58, 0
    v_sub_f32 v177, 0, v183
    v_mov_b32 v59, 0
    v_sub_f32 v178, 0, v183
    v_mov_b32 v60, 0
    v_sub_f32 v179, 0, v183
    v_mov_b32 v61, 0
    v_sub_f32 v180, 0, v183
    v_mov_b32 v62, 0
    v_sub_f32 v181, 0, v183
    v_mov_b32 v63, 0
    s_mov_b32 s51, 0
L_fb2:
    s_lshl_b32 s49, s51, 13
    buffer_load_dwordx4 v[72:75], v182, s[16:19], s49 offen sc1
    s_mov_b64 exec, s[56:57]
    buffer_load_dwordx4 v[76:79], v182, s[16:19], s49 offen offset:1024 sc1
    buffer_load_dwordx4 v[80:83], v182, s[16:19], s49 offen offset:1280 sc1
    s_mov_b64 exec, -1
    s_waitcnt vmcnt(0)
    v_mfma_f32_32x32x16_bf16 v[150:165], v[72:75], v[68:71], v[166:181]
    s_nop 11
    v_exp_f32 v150, v150
    v_exp_f32 v151, v151
    v_exp_f32 v152, v152
    v_exp_f32 v153, v153
    v_exp_f32 v154, v154
    v_exp_f32 v155, v155
    v_exp_f32 v156, v156
    v_exp_f32 v157, v157
    v_exp_f32 v158, v158
    v_exp_f32 v159, v159
    v_exp_f32 v160, v160
    v_exp_f32 v161, v161
    v_exp_f32 v162, v162
    v_exp_f32 v163, v163
    v_exp_f32 v164, v164
    v_exp_f32 v165, v165
    v_smfmac_f32_32x32x32_bf16 v[48:63], v[76:79], v[150:157], v6
    s_nop 0
    v_smfmac_f32_32x32x32_bf16 v[48:63], v[80:83], v[158:165], v6
    s_add_u32 s51, s51, 1
    s_cmp_lt_u32 s51, 64
    s_cbranch_scc1 L_fb2
    s_nop 15
    v_rcp_f32 v56, v56
    s_nop 1
    s_branch L_fallback_ret
L_end:
    s_endpgm
.section .rodata,"a"
.p2align 6
.amdhsa_kernel recurrent_scan__softmax_full_mha__moe_arch_mod__prompt_kernel
  .amdhsa_next_free_vgpr 256
  .amdhsa_next_free_sgpr 102
  .amdhsa_accum_offset 256
  .amdhsa_group_segment_fixed_size 0
  .amdhsa_kernarg_size 88
  .amdhsa_user_sgpr_count 2
  .amdhsa_user_sgpr_kernarg_segment_ptr 1
  .amdhsa_system_sgpr_workgroup_id_x 1
.end_amdhsa_kernel
```
